```python
import torch

def _softmax(x, axis=-1):
    return torch.softmax(x, dim=axis)
def _gelu(x):
    return torch.nn.functional.gelu(x, approximate="tanh")
def _silu(x):
    return torch.nn.functional.silu(x)
def _sigmoid(x):
    return torch.sigmoid(x)
def _layernorm(x, axis=-1, eps=1e-5):
    m = x.mean(dim=axis, keepdim=True)
    v = x.var(dim=axis, keepdim=True, unbiased=False)
    return (x - m) / torch.sqrt(v + eps)
def _scatter_add(tgt, idx, src, axis=0):
    return tgt.clone().index_add_(axis, idx, src)
def _segment_sum(src, seg, n):
    out = torch.zeros((n,) + src.shape[1:], dtype=src.dtype)
    return out.index_add_(0, seg, src)
def _pad(x, pw):
    flat = tuple(v for pair in reversed(pw) for v in pair)
    return torch.nn.functional.pad(x, flat)

kernel_name = 'standalone__softmax_full_bidir__decode'

def setup_inputs():

    _w = (lambda a: (lambda t: t.to(torch.bfloat16) if t.is_floating_point() else t)(torch.as_tensor(a)))
    B, H, Sq, Skv, Dh = 1, 32, 1, 32768, 192
    return {
        "q": _w((lambda *s: torch.randn(*s, dtype=torch.bfloat16) * 0.8)(B, H, Sq, Dh)),
        "k": _w((lambda *s: torch.randn(*s, dtype=torch.bfloat16) * 0.8)(B, H, Skv, Dh)),
        "v": _w((lambda *s: torch.randn(*s, dtype=torch.bfloat16) * 0.05)(B, H, Skv, Dh)),
    }

def reference(q, k, v):
    scale = q.shape[-1] ** -0.5
    scores = torch.einsum('bhqd,bhkd->bhqk', q, k) * scale
    attn = _softmax(scores, axis=-1)
    return torch.einsum('bhqk,bhkd->bhqd', attn, v)
```

```asm
; @launch kernel=attn_part_kernel grid=(1024,1,1) block=(256,1,1) lds=25088
; @launch kernel=attn_comb_kernel grid=(32,1,1) block=(256,1,1) lds=0
.amdgcn_target "amdgcn-amd-amdhsa--gfx950"
.text
.globl attn_part_kernel
.p2align 8
.type attn_part_kernel,@function
attn_part_kernel:
  s_cmp_ge_u32 s2, 1024
  s_cbranch_scc1 L_part_end
  s_load_dwordx2 s[4:5], s[0:1], 0
  s_load_dwordx2 s[8:9], s[0:1], 8
  s_load_dwordx2 s[12:13], s[0:1], 16
  s_load_dwordx2 s[16:17], s[0:1], 40
  v_lshrrev_b32 v2, 6, v0
  v_and_b32 v3, 63, v0
  v_readfirstlane_b32 s20, v2
  v_lshrrev_b32 v2, 3, v3
  v_and_b32 v3, 7, v3
  v_mul_u32_u24 v1, 384, v2
  v_lshl_add_u32 v1, v3, 4, v1
  s_lshl_b32 s21, s2, 2
  s_add_u32 s21, s21, s20
  s_mul_i32 s22, s21, 98304
  s_lshr_b32 s23, s2, 5
  s_mul_i32 s23, s23, 384
  v_lshlrev_b32 v120, 4, v3
  s_waitcnt lgkmcnt(0)
  s_mov_b32 s6, 12288
  s_mov_b32 s7, 0x00020000
  s_mov_b32 s10, 402653184
  s_mov_b32 s11, 0x00020000
  s_mov_b32 s14, 402653184
  s_mov_b32 s15, 0x00020000
  s_mov_b32 s18, 1056768
  s_mov_b32 s19, 0x00020000
  buffer_load_dwordx4 v[4:7], v120, s[4:7], s23 offen offset:0
  buffer_load_dwordx4 v[8:11], v120, s[4:7], s23 offen offset:128
  buffer_load_dwordx4 v[12:15], v120, s[4:7], s23 offen offset:256
  s_mov_b32 s24, s22
  buffer_load_dwordx4 v[60:63], v1, s[8:11], s24 offen offset:0 nt
  buffer_load_dwordx4 v[64:67], v1, s[8:11], s24 offen offset:128 nt
  buffer_load_dwordx4 v[68:71], v1, s[8:11], s24 offen offset:256 nt
  s_add_u32 s24, s24, 3072
  buffer_load_dwordx4 v[72:75], v1, s[8:11], s24 offen offset:0 nt
  buffer_load_dwordx4 v[76:79], v1, s[8:11], s24 offen offset:128 nt
  buffer_load_dwordx4 v[80:83], v1, s[8:11], s24 offen offset:256 nt
  s_add_u32 s24, s24, 3072
  buffer_load_dwordx4 v[84:87], v1, s[8:11], s24 offen offset:0 nt
  buffer_load_dwordx4 v[88:91], v1, s[8:11], s24 offen offset:128 nt
  buffer_load_dwordx4 v[92:95], v1, s[8:11], s24 offen offset:256 nt
  s_add_u32 s24, s24, 3072
  buffer_load_dwordx4 v[96:99], v1, s[8:11], s24 offen offset:0 nt
  buffer_load_dwordx4 v[100:103], v1, s[8:11], s24 offen offset:128 nt
  buffer_load_dwordx4 v[104:107], v1, s[8:11], s24 offen offset:256 nt
  s_add_u32 s24, s24, 3072
  buffer_load_dwordx4 v[108:111], v1, s[8:11], s24 offen offset:0 nt
  buffer_load_dwordx4 v[112:115], v1, s[8:11], s24 offen offset:128 nt
  buffer_load_dwordx4 v[116:119], v1, s[8:11], s24 offen offset:256 nt
  s_add_u32 s24, s24, 3072
  s_waitcnt vmcnt(12)
  v_mov_b32 v28, 0
  v_dot2c_f32_bf16 v28, v60, v4
  v_dot2c_f32_bf16 v28, v61, v5
  v_dot2c_f32_bf16 v28, v62, v6
  v_dot2c_f32_bf16 v28, v63, v7
  v_dot2c_f32_bf16 v28, v64, v8
  v_dot2c_f32_bf16 v28, v65, v9
  v_dot2c_f32_bf16 v28, v66, v10
  v_dot2c_f32_bf16 v28, v67, v11
  v_dot2c_f32_bf16 v28, v68, v12
  v_dot2c_f32_bf16 v28, v69, v13
  v_dot2c_f32_bf16 v28, v70, v14
  v_dot2c_f32_bf16 v28, v71, v15
  buffer_load_dwordx4 v[60:63], v1, s[8:11], s24 offen offset:0 nt
  buffer_load_dwordx4 v[64:67], v1, s[8:11], s24 offen offset:128 nt
  buffer_load_dwordx4 v[68:71], v1, s[8:11], s24 offen offset:256 nt
  s_add_u32 s24, s24, 3072
  s_waitcnt vmcnt(12)
  v_mov_b32 v29, 0
  v_dot2c_f32_bf16 v29, v72, v4
  v_dot2c_f32_bf16 v29, v73, v5
  v_dot2c_f32_bf16 v29, v74, v6
  v_dot2c_f32_bf16 v29, v75, v7
  v_dot2c_f32_bf16 v29, v76, v8
  v_dot2c_f32_bf16 v29, v77, v9
  v_dot2c_f32_bf16 v29, v78, v10
  v_dot2c_f32_bf16 v29, v79, v11
  v_dot2c_f32_bf16 v29, v80, v12
  v_dot2c_f32_bf16 v29, v81, v13
  v_dot2c_f32_bf16 v29, v82, v14
  v_dot2c_f32_bf16 v29, v83, v15
  buffer_load_dwordx4 v[72:75], v1, s[8:11], s24 offen offset:0 nt
  buffer_load_dwordx4 v[76:79], v1, s[8:11], s24 offen offset:128 nt
  buffer_load_dwordx4 v[80:83], v1, s[8:11], s24 offen offset:256 nt
  s_add_u32 s24, s24, 3072
  s_waitcnt vmcnt(12)
  v_mov_b32 v30, 0
  v_dot2c_f32_bf16 v30, v84, v4
  v_dot2c_f32_bf16 v30, v85, v5
  v_dot2c_f32_bf16 v30, v86, v6
  v_dot2c_f32_bf16 v30, v87, v7
  v_dot2c_f32_bf16 v30, v88, v8
  v_dot2c_f32_bf16 v30, v89, v9
  v_dot2c_f32_bf16 v30, v90, v10
  v_dot2c_f32_bf16 v30, v91, v11
  v_dot2c_f32_bf16 v30, v92, v12
  v_dot2c_f32_bf16 v30, v93, v13
  v_dot2c_f32_bf16 v30, v94, v14
  v_dot2c_f32_bf16 v30, v95, v15
  buffer_load_dwordx4 v[84:87], v1, s[8:11], s24 offen offset:0 nt
  buffer_load_dwordx4 v[88:91], v1, s[8:11], s24 offen offset:128 nt
  buffer_load_dwordx4 v[92:95], v1, s[8:11], s24 offen offset:256 nt
  s_add_u32 s24, s24, 3072
  s_waitcnt vmcnt(12)
  v_mov_b32 v31, 0
  v_dot2c_f32_bf16 v31, v96, v4
  v_dot2c_f32_bf16 v31, v97, v5
  v_dot2c_f32_bf16 v31, v98, v6
  v_dot2c_f32_bf16 v31, v99, v7
  v_dot2c_f32_bf16 v31, v100, v8
  v_dot2c_f32_bf16 v31, v101, v9
  v_dot2c_f32_bf16 v31, v102, v10
  v_dot2c_f32_bf16 v31, v103, v11
  v_dot2c_f32_bf16 v31, v104, v12
  v_dot2c_f32_bf16 v31, v105, v13
  v_dot2c_f32_bf16 v31, v106, v14
  v_dot2c_f32_bf16 v31, v107, v15
  buffer_load_dwordx4 v[96:99], v1, s[8:11], s24 offen offset:0 nt
  buffer_load_dwordx4 v[100:103], v1, s[8:11], s24 offen offset:128 nt
  buffer_load_dwordx4 v[104:107], v1, s[8:11], s24 offen offset:256 nt
  s_add_u32 s24, s24, 3072
  s_waitcnt vmcnt(12)
  v_mov_b32 v32, 0
  v_dot2c_f32_bf16 v32, v108, v4
  v_dot2c_f32_bf16 v32, v109, v5
  v_dot2c_f32_bf16 v32, v110, v6
  v_dot2c_f32_bf16 v32, v111, v7
  v_dot2c_f32_bf16 v32, v112, v8
  v_dot2c_f32_bf16 v32, v113, v9
  v_dot2c_f32_bf16 v32, v114, v10
  v_dot2c_f32_bf16 v32, v115, v11
  v_dot2c_f32_bf16 v32, v116, v12
  v_dot2c_f32_bf16 v32, v117, v13
  v_dot2c_f32_bf16 v32, v118, v14
  v_dot2c_f32_bf16 v32, v119, v15
  buffer_load_dwordx4 v[108:111], v1, s[8:11], s24 offen offset:0 nt
  buffer_load_dwordx4 v[112:115], v1, s[8:11], s24 offen offset:128 nt
  buffer_load_dwordx4 v[116:119], v1, s[8:11], s24 offen offset:256 nt
  s_add_u32 s24, s24, 3072
  s_waitcnt vmcnt(12)
  v_mov_b32 v33, 0
  v_dot2c_f32_bf16 v33, v60, v4
  v_dot2c_f32_bf16 v33, v61, v5
  v_dot2c_f32_bf16 v33, v62, v6
  v_dot2c_f32_bf16 v33, v63, v7
  v_dot2c_f32_bf16 v33, v64, v8
  v_dot2c_f32_bf16 v33, v65, v9
  v_dot2c_f32_bf16 v33, v66, v10
  v_dot2c_f32_bf16 v33, v67, v11
  v_dot2c_f32_bf16 v33, v68, v12
  v_dot2c_f32_bf16 v33, v69, v13
  v_dot2c_f32_bf16 v33, v70, v14
  v_dot2c_f32_bf16 v33, v71, v15
  buffer_load_dwordx4 v[60:63], v1, s[8:11], s24 offen offset:0 nt
  buffer_load_dwordx4 v[64:67], v1, s[8:11], s24 offen offset:128 nt
  buffer_load_dwordx4 v[68:71], v1, s[8:11], s24 offen offset:256 nt
  s_add_u32 s24, s24, 3072
  s_waitcnt vmcnt(12)
  v_mov_b32 v34, 0
  v_dot2c_f32_bf16 v34, v72, v4
  v_dot2c_f32_bf16 v34, v73, v5
  v_dot2c_f32_bf16 v34, v74, v6
  v_dot2c_f32_bf16 v34, v75, v7
  v_dot2c_f32_bf16 v34, v76, v8
  v_dot2c_f32_bf16 v34, v77, v9
  v_dot2c_f32_bf16 v34, v78, v10
  v_dot2c_f32_bf16 v34, v79, v11
  v_dot2c_f32_bf16 v34, v80, v12
  v_dot2c_f32_bf16 v34, v81, v13
  v_dot2c_f32_bf16 v34, v82, v14
  v_dot2c_f32_bf16 v34, v83, v15
  buffer_load_dwordx4 v[72:75], v1, s[8:11], s24 offen offset:0 nt
  buffer_load_dwordx4 v[76:79], v1, s[8:11], s24 offen offset:128 nt
  buffer_load_dwordx4 v[80:83], v1, s[8:11], s24 offen offset:256 nt
  s_add_u32 s24, s24, 3072
  s_waitcnt vmcnt(12)
  v_mov_b32 v35, 0
  v_dot2c_f32_bf16 v35, v84, v4
  v_dot2c_f32_bf16 v35, v85, v5
  v_dot2c_f32_bf16 v35, v86, v6
  v_dot2c_f32_bf16 v35, v87, v7
  v_dot2c_f32_bf16 v35, v88, v8
  v_dot2c_f32_bf16 v35, v89, v9
  v_dot2c_f32_bf16 v35, v90, v10
  v_dot2c_f32_bf16 v35, v91, v11
  v_dot2c_f32_bf16 v35, v92, v12
  v_dot2c_f32_bf16 v35, v93, v13
  v_dot2c_f32_bf16 v35, v94, v14
  v_dot2c_f32_bf16 v35, v95, v15
  buffer_load_dwordx4 v[84:87], v1, s[8:11], s24 offen offset:0 nt
  buffer_load_dwordx4 v[88:91], v1, s[8:11], s24 offen offset:128 nt
  buffer_load_dwordx4 v[92:95], v1, s[8:11], s24 offen offset:256 nt
  s_add_u32 s24, s24, 3072
  s_waitcnt vmcnt(12)
  v_mov_b32 v36, 0
  v_dot2c_f32_bf16 v36, v96, v4
  v_dot2c_f32_bf16 v36, v97, v5
  v_dot2c_f32_bf16 v36, v98, v6
  v_dot2c_f32_bf16 v36, v99, v7
  v_dot2c_f32_bf16 v36, v100, v8
  v_dot2c_f32_bf16 v36, v101, v9
  v_dot2c_f32_bf16 v36, v102, v10
  v_dot2c_f32_bf16 v36, v103, v11
  v_dot2c_f32_bf16 v36, v104, v12
  v_dot2c_f32_bf16 v36, v105, v13
  v_dot2c_f32_bf16 v36, v106, v14
  v_dot2c_f32_bf16 v36, v107, v15
  buffer_load_dwordx4 v[96:99], v1, s[8:11], s24 offen offset:0 nt
  buffer_load_dwordx4 v[100:103], v1, s[8:11], s24 offen offset:128 nt
  buffer_load_dwordx4 v[104:107], v1, s[8:11], s24 offen offset:256 nt
  s_add_u32 s24, s24, 3072
  s_waitcnt vmcnt(12)
  v_mov_b32 v37, 0
  v_dot2c_f32_bf16 v37, v108, v4
  v_dot2c_f32_bf16 v37, v109, v5
  v_dot2c_f32_bf16 v37, v110, v6
  v_dot2c_f32_bf16 v37, v111, v7
  v_dot2c_f32_bf16 v37, v112, v8
  v_dot2c_f32_bf16 v37, v113, v9
  v_dot2c_f32_bf16 v37, v114, v10
  v_dot2c_f32_bf16 v37, v115, v11
  v_dot2c_f32_bf16 v37, v116, v12
  v_dot2c_f32_bf16 v37, v117, v13
  v_dot2c_f32_bf16 v37, v118, v14
  v_dot2c_f32_bf16 v37, v119, v15
  buffer_load_dwordx4 v[108:111], v1, s[8:11], s24 offen offset:0 nt
  buffer_load_dwordx4 v[112:115], v1, s[8:11], s24 offen offset:128 nt
  buffer_load_dwordx4 v[116:119], v1, s[8:11], s24 offen offset:256 nt
  s_add_u32 s24, s24, 3072
  s_waitcnt vmcnt(12)
  v_mov_b32 v38, 0
  v_dot2c_f32_bf16 v38, v60, v4
  v_dot2c_f32_bf16 v38, v61, v5
  v_dot2c_f32_bf16 v38, v62, v6
  v_dot2c_f32_bf16 v38, v63, v7
  v_dot2c_f32_bf16 v38, v64, v8
  v_dot2c_f32_bf16 v38, v65, v9
  v_dot2c_f32_bf16 v38, v66, v10
  v_dot2c_f32_bf16 v38, v67, v11
  v_dot2c_f32_bf16 v38, v68, v12
  v_dot2c_f32_bf16 v38, v69, v13
  v_dot2c_f32_bf16 v38, v70, v14
  v_dot2c_f32_bf16 v38, v71, v15
  buffer_load_dwordx4 v[60:63], v1, s[8:11], s24 offen offset:0 nt
  buffer_load_dwordx4 v[64:67], v1, s[8:11], s24 offen offset:128 nt
  buffer_load_dwordx4 v[68:71], v1, s[8:11], s24 offen offset:256 nt
  s_add_u32 s24, s24, 3072
  s_waitcnt vmcnt(12)
  v_mov_b32 v39, 0
  v_dot2c_f32_bf16 v39, v72, v4
  v_dot2c_f32_bf16 v39, v73, v5
  v_dot2c_f32_bf16 v39, v74, v6
  v_dot2c_f32_bf16 v39, v75, v7
  v_dot2c_f32_bf16 v39, v76, v8
  v_dot2c_f32_bf16 v39, v77, v9
  v_dot2c_f32_bf16 v39, v78, v10
  v_dot2c_f32_bf16 v39, v79, v11
  v_dot2c_f32_bf16 v39, v80, v12
  v_dot2c_f32_bf16 v39, v81, v13
  v_dot2c_f32_bf16 v39, v82, v14
  v_dot2c_f32_bf16 v39, v83, v15
  buffer_load_dwordx4 v[72:75], v1, s[8:11], s24 offen offset:0 nt
  buffer_load_dwordx4 v[76:79], v1, s[8:11], s24 offen offset:128 nt
  buffer_load_dwordx4 v[80:83], v1, s[8:11], s24 offen offset:256 nt
  s_add_u32 s24, s24, 3072
  s_waitcnt vmcnt(12)
  v_mov_b32 v40, 0
  v_dot2c_f32_bf16 v40, v84, v4
  v_dot2c_f32_bf16 v40, v85, v5
  v_dot2c_f32_bf16 v40, v86, v6
  v_dot2c_f32_bf16 v40, v87, v7
  v_dot2c_f32_bf16 v40, v88, v8
  v_dot2c_f32_bf16 v40, v89, v9
  v_dot2c_f32_bf16 v40, v90, v10
  v_dot2c_f32_bf16 v40, v91, v11
  v_dot2c_f32_bf16 v40, v92, v12
  v_dot2c_f32_bf16 v40, v93, v13
  v_dot2c_f32_bf16 v40, v94, v14
  v_dot2c_f32_bf16 v40, v95, v15
  buffer_load_dwordx4 v[84:87], v1, s[8:11], s24 offen offset:0 nt
  buffer_load_dwordx4 v[88:91], v1, s[8:11], s24 offen offset:128 nt
  buffer_load_dwordx4 v[92:95], v1, s[8:11], s24 offen offset:256 nt
  s_add_u32 s24, s24, 3072
  s_waitcnt vmcnt(12)
  v_mov_b32 v41, 0
  v_dot2c_f32_bf16 v41, v96, v4
  v_dot2c_f32_bf16 v41, v97, v5
  v_dot2c_f32_bf16 v41, v98, v6
  v_dot2c_f32_bf16 v41, v99, v7
  v_dot2c_f32_bf16 v41, v100, v8
  v_dot2c_f32_bf16 v41, v101, v9
  v_dot2c_f32_bf16 v41, v102, v10
  v_dot2c_f32_bf16 v41, v103, v11
  v_dot2c_f32_bf16 v41, v104, v12
  v_dot2c_f32_bf16 v41, v105, v13
  v_dot2c_f32_bf16 v41, v106, v14
  v_dot2c_f32_bf16 v41, v107, v15
  buffer_load_dwordx4 v[96:99], v1, s[8:11], s24 offen offset:0 nt
  buffer_load_dwordx4 v[100:103], v1, s[8:11], s24 offen offset:128 nt
  buffer_load_dwordx4 v[104:107], v1, s[8:11], s24 offen offset:256 nt
  s_add_u32 s24, s24, 3072
  s_waitcnt vmcnt(12)
  v_mov_b32 v42, 0
  v_dot2c_f32_bf16 v42, v108, v4
  v_dot2c_f32_bf16 v42, v109, v5
  v_dot2c_f32_bf16 v42, v110, v6
  v_dot2c_f32_bf16 v42, v111, v7
  v_dot2c_f32_bf16 v42, v112, v8
  v_dot2c_f32_bf16 v42, v113, v9
  v_dot2c_f32_bf16 v42, v114, v10
  v_dot2c_f32_bf16 v42, v115, v11
  v_dot2c_f32_bf16 v42, v116, v12
  v_dot2c_f32_bf16 v42, v117, v13
  v_dot2c_f32_bf16 v42, v118, v14
  v_dot2c_f32_bf16 v42, v119, v15
  buffer_load_dwordx4 v[108:111], v1, s[8:11], s24 offen offset:0 nt
  buffer_load_dwordx4 v[112:115], v1, s[8:11], s24 offen offset:128 nt
  buffer_load_dwordx4 v[116:119], v1, s[8:11], s24 offen offset:256 nt
  s_add_u32 s24, s24, 3072
  s_waitcnt vmcnt(12)
  v_mov_b32 v43, 0
  v_dot2c_f32_bf16 v43, v60, v4
  v_dot2c_f32_bf16 v43, v61, v5
  v_dot2c_f32_bf16 v43, v62, v6
  v_dot2c_f32_bf16 v43, v63, v7
  v_dot2c_f32_bf16 v43, v64, v8
  v_dot2c_f32_bf16 v43, v65, v9
  v_dot2c_f32_bf16 v43, v66, v10
  v_dot2c_f32_bf16 v43, v67, v11
  v_dot2c_f32_bf16 v43, v68, v12
  v_dot2c_f32_bf16 v43, v69, v13
  v_dot2c_f32_bf16 v43, v70, v14
  v_dot2c_f32_bf16 v43, v71, v15
  buffer_load_dwordx4 v[60:63], v1, s[8:11], s24 offen offset:0 nt
  buffer_load_dwordx4 v[64:67], v1, s[8:11], s24 offen offset:128 nt
  buffer_load_dwordx4 v[68:71], v1, s[8:11], s24 offen offset:256 nt
  s_add_u32 s24, s24, 3072
  s_waitcnt vmcnt(12)
  v_mov_b32 v44, 0
  v_dot2c_f32_bf16 v44, v72, v4
  v_dot2c_f32_bf16 v44, v73, v5
  v_dot2c_f32_bf16 v44, v74, v6
  v_dot2c_f32_bf16 v44, v75, v7
  v_dot2c_f32_bf16 v44, v76, v8
  v_dot2c_f32_bf16 v44, v77, v9
  v_dot2c_f32_bf16 v44, v78, v10
  v_dot2c_f32_bf16 v44, v79, v11
  v_dot2c_f32_bf16 v44, v80, v12
  v_dot2c_f32_bf16 v44, v81, v13
  v_dot2c_f32_bf16 v44, v82, v14
  v_dot2c_f32_bf16 v44, v83, v15
  buffer_load_dwordx4 v[72:75], v1, s[8:11], s24 offen offset:0 nt
  buffer_load_dwordx4 v[76:79], v1, s[8:11], s24 offen offset:128 nt
  buffer_load_dwordx4 v[80:83], v1, s[8:11], s24 offen offset:256 nt
  s_add_u32 s24, s24, 3072
  s_waitcnt vmcnt(12)
  v_mov_b32 v45, 0
  v_dot2c_f32_bf16 v45, v84, v4
  v_dot2c_f32_bf16 v45, v85, v5
  v_dot2c_f32_bf16 v45, v86, v6
  v_dot2c_f32_bf16 v45, v87, v7
  v_dot2c_f32_bf16 v45, v88, v8
  v_dot2c_f32_bf16 v45, v89, v9
  v_dot2c_f32_bf16 v45, v90, v10
  v_dot2c_f32_bf16 v45, v91, v11
  v_dot2c_f32_bf16 v45, v92, v12
  v_dot2c_f32_bf16 v45, v93, v13
  v_dot2c_f32_bf16 v45, v94, v14
  v_dot2c_f32_bf16 v45, v95, v15
  buffer_load_dwordx4 v[84:87], v1, s[8:11], s24 offen offset:0 nt
  buffer_load_dwordx4 v[88:91], v1, s[8:11], s24 offen offset:128 nt
  buffer_load_dwordx4 v[92:95], v1, s[8:11], s24 offen offset:256 nt
  s_add_u32 s24, s24, 3072
  s_waitcnt vmcnt(12)
  v_mov_b32 v46, 0
  v_dot2c_f32_bf16 v46, v96, v4
  v_dot2c_f32_bf16 v46, v97, v5
  v_dot2c_f32_bf16 v46, v98, v6
  v_dot2c_f32_bf16 v46, v99, v7
  v_dot2c_f32_bf16 v46, v100, v8
  v_dot2c_f32_bf16 v46, v101, v9
  v_dot2c_f32_bf16 v46, v102, v10
  v_dot2c_f32_bf16 v46, v103, v11
  v_dot2c_f32_bf16 v46, v104, v12
  v_dot2c_f32_bf16 v46, v105, v13
  v_dot2c_f32_bf16 v46, v106, v14
  v_dot2c_f32_bf16 v46, v107, v15
  buffer_load_dwordx4 v[96:99], v1, s[8:11], s24 offen offset:0 nt
  buffer_load_dwordx4 v[100:103], v1, s[8:11], s24 offen offset:128 nt
  buffer_load_dwordx4 v[104:107], v1, s[8:11], s24 offen offset:256 nt
  s_add_u32 s24, s24, 3072
  s_waitcnt vmcnt(12)
  v_mov_b32 v47, 0
  v_dot2c_f32_bf16 v47, v108, v4
  v_dot2c_f32_bf16 v47, v109, v5
  v_dot2c_f32_bf16 v47, v110, v6
  v_dot2c_f32_bf16 v47, v111, v7
  v_dot2c_f32_bf16 v47, v112, v8
  v_dot2c_f32_bf16 v47, v113, v9
  v_dot2c_f32_bf16 v47, v114, v10
  v_dot2c_f32_bf16 v47, v115, v11
  v_dot2c_f32_bf16 v47, v116, v12
  v_dot2c_f32_bf16 v47, v117, v13
  v_dot2c_f32_bf16 v47, v118, v14
  v_dot2c_f32_bf16 v47, v119, v15
  buffer_load_dwordx4 v[108:111], v1, s[8:11], s24 offen offset:0 nt
  buffer_load_dwordx4 v[112:115], v1, s[8:11], s24 offen offset:128 nt
  buffer_load_dwordx4 v[116:119], v1, s[8:11], s24 offen offset:256 nt
  s_add_u32 s24, s24, 3072
  s_waitcnt vmcnt(12)
  v_mov_b32 v48, 0
  v_dot2c_f32_bf16 v48, v60, v4
  v_dot2c_f32_bf16 v48, v61, v5
  v_dot2c_f32_bf16 v48, v62, v6
  v_dot2c_f32_bf16 v48, v63, v7
  v_dot2c_f32_bf16 v48, v64, v8
  v_dot2c_f32_bf16 v48, v65, v9
  v_dot2c_f32_bf16 v48, v66, v10
  v_dot2c_f32_bf16 v48, v67, v11
  v_dot2c_f32_bf16 v48, v68, v12
  v_dot2c_f32_bf16 v48, v69, v13
  v_dot2c_f32_bf16 v48, v70, v14
  v_dot2c_f32_bf16 v48, v71, v15
  buffer_load_dwordx4 v[60:63], v1, s[8:11], s24 offen offset:0 nt
  buffer_load_dwordx4 v[64:67], v1, s[8:11], s24 offen offset:128 nt
  buffer_load_dwordx4 v[68:71], v1, s[8:11], s24 offen offset:256 nt
  s_add_u32 s24, s24, 3072
  s_waitcnt vmcnt(12)
  v_mov_b32 v49, 0
  v_dot2c_f32_bf16 v49, v72, v4
  v_dot2c_f32_bf16 v49, v73, v5
  v_dot2c_f32_bf16 v49, v74, v6
  v_dot2c_f32_bf16 v49, v75, v7
  v_dot2c_f32_bf16 v49, v76, v8
  v_dot2c_f32_bf16 v49, v77, v9
  v_dot2c_f32_bf16 v49, v78, v10
  v_dot2c_f32_bf16 v49, v79, v11
  v_dot2c_f32_bf16 v49, v80, v12
  v_dot2c_f32_bf16 v49, v81, v13
  v_dot2c_f32_bf16 v49, v82, v14
  v_dot2c_f32_bf16 v49, v83, v15
  buffer_load_dwordx4 v[72:75], v1, s[8:11], s24 offen offset:0 nt
  buffer_load_dwordx4 v[76:79], v1, s[8:11], s24 offen offset:128 nt
  buffer_load_dwordx4 v[80:83], v1, s[8:11], s24 offen offset:256 nt
  s_add_u32 s24, s24, 3072
  s_waitcnt vmcnt(12)
  v_mov_b32 v50, 0
  v_dot2c_f32_bf16 v50, v84, v4
  v_dot2c_f32_bf16 v50, v85, v5
  v_dot2c_f32_bf16 v50, v86, v6
  v_dot2c_f32_bf16 v50, v87, v7
  v_dot2c_f32_bf16 v50, v88, v8
  v_dot2c_f32_bf16 v50, v89, v9
  v_dot2c_f32_bf16 v50, v90, v10
  v_dot2c_f32_bf16 v50, v91, v11
  v_dot2c_f32_bf16 v50, v92, v12
  v_dot2c_f32_bf16 v50, v93, v13
  v_dot2c_f32_bf16 v50, v94, v14
  v_dot2c_f32_bf16 v50, v95, v15
  buffer_load_dwordx4 v[84:87], v1, s[8:11], s24 offen offset:0 nt
  buffer_load_dwordx4 v[88:91], v1, s[8:11], s24 offen offset:128 nt
  buffer_load_dwordx4 v[92:95], v1, s[8:11], s24 offen offset:256 nt
  s_add_u32 s24, s24, 3072
  s_waitcnt vmcnt(12)
  v_mov_b32 v51, 0
  v_dot2c_f32_bf16 v51, v96, v4
  v_dot2c_f32_bf16 v51, v97, v5
  v_dot2c_f32_bf16 v51, v98, v6
  v_dot2c_f32_bf16 v51, v99, v7
  v_dot2c_f32_bf16 v51, v100, v8
  v_dot2c_f32_bf16 v51, v101, v9
  v_dot2c_f32_bf16 v51, v102, v10
  v_dot2c_f32_bf16 v51, v103, v11
  v_dot2c_f32_bf16 v51, v104, v12
  v_dot2c_f32_bf16 v51, v105, v13
  v_dot2c_f32_bf16 v51, v106, v14
  v_dot2c_f32_bf16 v51, v107, v15
  buffer_load_dwordx4 v[96:99], v1, s[8:11], s24 offen offset:0 nt
  buffer_load_dwordx4 v[100:103], v1, s[8:11], s24 offen offset:128 nt
  buffer_load_dwordx4 v[104:107], v1, s[8:11], s24 offen offset:256 nt
  s_add_u32 s24, s24, 3072
  s_waitcnt vmcnt(12)
  v_mov_b32 v52, 0
  v_dot2c_f32_bf16 v52, v108, v4
  v_dot2c_f32_bf16 v52, v109, v5
  v_dot2c_f32_bf16 v52, v110, v6
  v_dot2c_f32_bf16 v52, v111, v7
  v_dot2c_f32_bf16 v52, v112, v8
  v_dot2c_f32_bf16 v52, v113, v9
  v_dot2c_f32_bf16 v52, v114, v10
  v_dot2c_f32_bf16 v52, v115, v11
  v_dot2c_f32_bf16 v52, v116, v12
  v_dot2c_f32_bf16 v52, v117, v13
  v_dot2c_f32_bf16 v52, v118, v14
  v_dot2c_f32_bf16 v52, v119, v15
  buffer_load_dwordx4 v[108:111], v1, s[8:11], s24 offen offset:0 nt
  buffer_load_dwordx4 v[112:115], v1, s[8:11], s24 offen offset:128 nt
  buffer_load_dwordx4 v[116:119], v1, s[8:11], s24 offen offset:256 nt
  s_add_u32 s24, s24, 3072
  s_waitcnt vmcnt(12)
  v_mov_b32 v53, 0
  v_dot2c_f32_bf16 v53, v60, v4
  v_dot2c_f32_bf16 v53, v61, v5
  v_dot2c_f32_bf16 v53, v62, v6
  v_dot2c_f32_bf16 v53, v63, v7
  v_dot2c_f32_bf16 v53, v64, v8
  v_dot2c_f32_bf16 v53, v65, v9
  v_dot2c_f32_bf16 v53, v66, v10
  v_dot2c_f32_bf16 v53, v67, v11
  v_dot2c_f32_bf16 v53, v68, v12
  v_dot2c_f32_bf16 v53, v69, v13
  v_dot2c_f32_bf16 v53, v70, v14
  v_dot2c_f32_bf16 v53, v71, v15
  buffer_load_dwordx4 v[60:63], v1, s[8:11], s24 offen offset:0 nt
  buffer_load_dwordx4 v[64:67], v1, s[8:11], s24 offen offset:128 nt
  buffer_load_dwordx4 v[68:71], v1, s[8:11], s24 offen offset:256 nt
  s_add_u32 s24, s24, 3072
  s_waitcnt vmcnt(12)
  v_mov_b32 v54, 0
  v_dot2c_f32_bf16 v54, v72, v4
  v_dot2c_f32_bf16 v54, v73, v5
  v_dot2c_f32_bf16 v54, v74, v6
  v_dot2c_f32_bf16 v54, v75, v7
  v_dot2c_f32_bf16 v54, v76, v8
  v_dot2c_f32_bf16 v54, v77, v9
  v_dot2c_f32_bf16 v54, v78, v10
  v_dot2c_f32_bf16 v54, v79, v11
  v_dot2c_f32_bf16 v54, v80, v12
  v_dot2c_f32_bf16 v54, v81, v13
  v_dot2c_f32_bf16 v54, v82, v14
  v_dot2c_f32_bf16 v54, v83, v15
  buffer_load_dwordx4 v[72:75], v1, s[8:11], s24 offen offset:0 nt
  buffer_load_dwordx4 v[76:79], v1, s[8:11], s24 offen offset:128 nt
  buffer_load_dwordx4 v[80:83], v1, s[8:11], s24 offen offset:256 nt
  s_add_u32 s24, s24, 3072
  s_waitcnt vmcnt(12)
  v_mov_b32 v55, 0
  v_dot2c_f32_bf16 v55, v84, v4
  v_dot2c_f32_bf16 v55, v85, v5
  v_dot2c_f32_bf16 v55, v86, v6
  v_dot2c_f32_bf16 v55, v87, v7
  v_dot2c_f32_bf16 v55, v88, v8
  v_dot2c_f32_bf16 v55, v89, v9
  v_dot2c_f32_bf16 v55, v90, v10
  v_dot2c_f32_bf16 v55, v91, v11
  v_dot2c_f32_bf16 v55, v92, v12
  v_dot2c_f32_bf16 v55, v93, v13
  v_dot2c_f32_bf16 v55, v94, v14
  v_dot2c_f32_bf16 v55, v95, v15
  s_mov_b32 s24, s22
  buffer_load_dwordx4 v[84:87], v1, s[12:15], s24 offen offset:0 nt
  buffer_load_dwordx4 v[88:91], v1, s[12:15], s24 offen offset:128 nt
  buffer_load_dwordx4 v[92:95], v1, s[12:15], s24 offen offset:256 nt
  s_add_u32 s24, s24, 3072
  s_waitcnt vmcnt(12)
  v_mov_b32 v56, 0
  v_dot2c_f32_bf16 v56, v96, v4
  v_dot2c_f32_bf16 v56, v97, v5
  v_dot2c_f32_bf16 v56, v98, v6
  v_dot2c_f32_bf16 v56, v99, v7
  v_dot2c_f32_bf16 v56, v100, v8
  v_dot2c_f32_bf16 v56, v101, v9
  v_dot2c_f32_bf16 v56, v102, v10
  v_dot2c_f32_bf16 v56, v103, v11
  v_dot2c_f32_bf16 v56, v104, v12
  v_dot2c_f32_bf16 v56, v105, v13
  v_dot2c_f32_bf16 v56, v106, v14
  v_dot2c_f32_bf16 v56, v107, v15
  buffer_load_dwordx4 v[96:99], v1, s[12:15], s24 offen offset:0 nt
  buffer_load_dwordx4 v[100:103], v1, s[12:15], s24 offen offset:128 nt
  buffer_load_dwordx4 v[104:107], v1, s[12:15], s24 offen offset:256 nt
  s_add_u32 s24, s24, 3072
  s_waitcnt vmcnt(12)
  v_mov_b32 v57, 0
  v_dot2c_f32_bf16 v57, v108, v4
  v_dot2c_f32_bf16 v57, v109, v5
  v_dot2c_f32_bf16 v57, v110, v6
  v_dot2c_f32_bf16 v57, v111, v7
  v_dot2c_f32_bf16 v57, v112, v8
  v_dot2c_f32_bf16 v57, v113, v9
  v_dot2c_f32_bf16 v57, v114, v10
  v_dot2c_f32_bf16 v57, v115, v11
  v_dot2c_f32_bf16 v57, v116, v12
  v_dot2c_f32_bf16 v57, v117, v13
  v_dot2c_f32_bf16 v57, v118, v14
  v_dot2c_f32_bf16 v57, v119, v15
  buffer_load_dwordx4 v[108:111], v1, s[12:15], s24 offen offset:0 nt
  buffer_load_dwordx4 v[112:115], v1, s[12:15], s24 offen offset:128 nt
  buffer_load_dwordx4 v[116:119], v1, s[12:15], s24 offen offset:256 nt
  s_add_u32 s24, s24, 3072
  s_waitcnt vmcnt(12)
  v_mov_b32 v58, 0
  v_dot2c_f32_bf16 v58, v60, v4
  v_dot2c_f32_bf16 v58, v61, v5
  v_dot2c_f32_bf16 v58, v62, v6
  v_dot2c_f32_bf16 v58, v63, v7
  v_dot2c_f32_bf16 v58, v64, v8
  v_dot2c_f32_bf16 v58, v65, v9
  v_dot2c_f32_bf16 v58, v66, v10
  v_dot2c_f32_bf16 v58, v67, v11
  v_dot2c_f32_bf16 v58, v68, v12
  v_dot2c_f32_bf16 v58, v69, v13
  v_dot2c_f32_bf16 v58, v70, v14
  v_dot2c_f32_bf16 v58, v71, v15
  buffer_load_dwordx4 v[60:63], v1, s[12:15], s24 offen offset:0 nt
  buffer_load_dwordx4 v[64:67], v1, s[12:15], s24 offen offset:128 nt
  buffer_load_dwordx4 v[68:71], v1, s[12:15], s24 offen offset:256 nt
  s_add_u32 s24, s24, 3072
  s_waitcnt vmcnt(12)
  v_mov_b32 v59, 0
  v_dot2c_f32_bf16 v59, v72, v4
  v_dot2c_f32_bf16 v59, v73, v5
  v_dot2c_f32_bf16 v59, v74, v6
  v_dot2c_f32_bf16 v59, v75, v7
  v_dot2c_f32_bf16 v59, v76, v8
  v_dot2c_f32_bf16 v59, v77, v9
  v_dot2c_f32_bf16 v59, v78, v10
  v_dot2c_f32_bf16 v59, v79, v11
  v_dot2c_f32_bf16 v59, v80, v12
  v_dot2c_f32_bf16 v59, v81, v13
  v_dot2c_f32_bf16 v59, v82, v14
  v_dot2c_f32_bf16 v59, v83, v15
  v_add_f32_dpp v28, v28, v28 quad_perm:[1,0,3,2] row_mask:0xf bank_mask:0xf
  v_add_f32_dpp v29, v29, v29 quad_perm:[1,0,3,2] row_mask:0xf bank_mask:0xf
  v_add_f32_dpp v30, v30, v30 quad_perm:[1,0,3,2] row_mask:0xf bank_mask:0xf
  v_add_f32_dpp v31, v31, v31 quad_perm:[1,0,3,2] row_mask:0xf bank_mask:0xf
  v_add_f32_dpp v32, v32, v32 quad_perm:[1,0,3,2] row_mask:0xf bank_mask:0xf
  v_add_f32_dpp v33, v33, v33 quad_perm:[1,0,3,2] row_mask:0xf bank_mask:0xf
  v_add_f32_dpp v34, v34, v34 quad_perm:[1,0,3,2] row_mask:0xf bank_mask:0xf
  v_add_f32_dpp v35, v35, v35 quad_perm:[1,0,3,2] row_mask:0xf bank_mask:0xf
  v_add_f32_dpp v36, v36, v36 quad_perm:[1,0,3,2] row_mask:0xf bank_mask:0xf
  v_add_f32_dpp v37, v37, v37 quad_perm:[1,0,3,2] row_mask:0xf bank_mask:0xf
  v_add_f32_dpp v38, v38, v38 quad_perm:[1,0,3,2] row_mask:0xf bank_mask:0xf
  v_add_f32_dpp v39, v39, v39 quad_perm:[1,0,3,2] row_mask:0xf bank_mask:0xf
  v_add_f32_dpp v40, v40, v40 quad_perm:[1,0,3,2] row_mask:0xf bank_mask:0xf
  v_add_f32_dpp v41, v41, v41 quad_perm:[1,0,3,2] row_mask:0xf bank_mask:0xf
  v_add_f32_dpp v42, v42, v42 quad_perm:[1,0,3,2] row_mask:0xf bank_mask:0xf
  v_add_f32_dpp v43, v43, v43 quad_perm:[1,0,3,2] row_mask:0xf bank_mask:0xf
  v_add_f32_dpp v44, v44, v44 quad_perm:[1,0,3,2] row_mask:0xf bank_mask:0xf
  v_add_f32_dpp v45, v45, v45 quad_perm:[1,0,3,2] row_mask:0xf bank_mask:0xf
  v_add_f32_dpp v46, v46, v46 quad_perm:[1,0,3,2] row_mask:0xf bank_mask:0xf
  v_add_f32_dpp v47, v47, v47 quad_perm:[1,0,3,2] row_mask:0xf bank_mask:0xf
  v_add_f32_dpp v48, v48, v48 quad_perm:[1,0,3,2] row_mask:0xf bank_mask:0xf
  v_add_f32_dpp v49, v49, v49 quad_perm:[1,0,3,2] row_mask:0xf bank_mask:0xf
  v_add_f32_dpp v50, v50, v50 quad_perm:[1,0,3,2] row_mask:0xf bank_mask:0xf
  v_add_f32_dpp v51, v51, v51 quad_perm:[1,0,3,2] row_mask:0xf bank_mask:0xf
  v_add_f32_dpp v52, v52, v52 quad_perm:[1,0,3,2] row_mask:0xf bank_mask:0xf
  v_add_f32_dpp v53, v53, v53 quad_perm:[1,0,3,2] row_mask:0xf bank_mask:0xf
  v_add_f32_dpp v54, v54, v54 quad_perm:[1,0,3,2] row_mask:0xf bank_mask:0xf
  v_add_f32_dpp v55, v55, v55 quad_perm:[1,0,3,2] row_mask:0xf bank_mask:0xf
  v_add_f32_dpp v56, v56, v56 quad_perm:[1,0,3,2] row_mask:0xf bank_mask:0xf
  v_add_f32_dpp v57, v57, v57 quad_perm:[1,0,3,2] row_mask:0xf bank_mask:0xf
  v_add_f32_dpp v58, v58, v58 quad_perm:[1,0,3,2] row_mask:0xf bank_mask:0xf
  v_add_f32_dpp v59, v59, v59 quad_perm:[1,0,3,2] row_mask:0xf bank_mask:0xf
  v_add_f32_dpp v28, v28, v28 quad_perm:[2,3,0,1] row_mask:0xf bank_mask:0xf
  v_add_f32_dpp v29, v29, v29 quad_perm:[2,3,0,1] row_mask:0xf bank_mask:0xf
  v_add_f32_dpp v30, v30, v30 quad_perm:[2,3,0,1] row_mask:0xf bank_mask:0xf
  v_add_f32_dpp v31, v31, v31 quad_perm:[2,3,0,1] row_mask:0xf bank_mask:0xf
  v_add_f32_dpp v32, v32, v32 quad_perm:[2,3,0,1] row_mask:0xf bank_mask:0xf
  v_add_f32_dpp v33, v33, v33 quad_perm:[2,3,0,1] row_mask:0xf bank_mask:0xf
  v_add_f32_dpp v34, v34, v34 quad_perm:[2,3,0,1] row_mask:0xf bank_mask:0xf
  v_add_f32_dpp v35, v35, v35 quad_perm:[2,3,0,1] row_mask:0xf bank_mask:0xf
  v_add_f32_dpp v36, v36, v36 quad_perm:[2,3,0,1] row_mask:0xf bank_mask:0xf
  v_add_f32_dpp v37, v37, v37 quad_perm:[2,3,0,1] row_mask:0xf bank_mask:0xf
  v_add_f32_dpp v38, v38, v38 quad_perm:[2,3,0,1] row_mask:0xf bank_mask:0xf
  v_add_f32_dpp v39, v39, v39 quad_perm:[2,3,0,1] row_mask:0xf bank_mask:0xf
  v_add_f32_dpp v40, v40, v40 quad_perm:[2,3,0,1] row_mask:0xf bank_mask:0xf
  v_add_f32_dpp v41, v41, v41 quad_perm:[2,3,0,1] row_mask:0xf bank_mask:0xf
  v_add_f32_dpp v42, v42, v42 quad_perm:[2,3,0,1] row_mask:0xf bank_mask:0xf
  v_add_f32_dpp v43, v43, v43 quad_perm:[2,3,0,1] row_mask:0xf bank_mask:0xf
  v_add_f32_dpp v44, v44, v44 quad_perm:[2,3,0,1] row_mask:0xf bank_mask:0xf
  v_add_f32_dpp v45, v45, v45 quad_perm:[2,3,0,1] row_mask:0xf bank_mask:0xf
  v_add_f32_dpp v46, v46, v46 quad_perm:[2,3,0,1] row_mask:0xf bank_mask:0xf
  v_add_f32_dpp v47, v47, v47 quad_perm:[2,3,0,1] row_mask:0xf bank_mask:0xf
  v_add_f32_dpp v48, v48, v48 quad_perm:[2,3,0,1] row_mask:0xf bank_mask:0xf
  v_add_f32_dpp v49, v49, v49 quad_perm:[2,3,0,1] row_mask:0xf bank_mask:0xf
  v_add_f32_dpp v50, v50, v50 quad_perm:[2,3,0,1] row_mask:0xf bank_mask:0xf
  v_add_f32_dpp v51, v51, v51 quad_perm:[2,3,0,1] row_mask:0xf bank_mask:0xf
  v_add_f32_dpp v52, v52, v52 quad_perm:[2,3,0,1] row_mask:0xf bank_mask:0xf
  v_add_f32_dpp v53, v53, v53 quad_perm:[2,3,0,1] row_mask:0xf bank_mask:0xf
  v_add_f32_dpp v54, v54, v54 quad_perm:[2,3,0,1] row_mask:0xf bank_mask:0xf
  v_add_f32_dpp v55, v55, v55 quad_perm:[2,3,0,1] row_mask:0xf bank_mask:0xf
  v_add_f32_dpp v56, v56, v56 quad_perm:[2,3,0,1] row_mask:0xf bank_mask:0xf
  v_add_f32_dpp v57, v57, v57 quad_perm:[2,3,0,1] row_mask:0xf bank_mask:0xf
  v_add_f32_dpp v58, v58, v58 quad_perm:[2,3,0,1] row_mask:0xf bank_mask:0xf
  v_add_f32_dpp v59, v59, v59 quad_perm:[2,3,0,1] row_mask:0xf bank_mask:0xf
  v_add_f32_dpp v28, v28, v28 row_half_mirror row_mask:0xf bank_mask:0xf
  v_add_f32_dpp v29, v29, v29 row_half_mirror row_mask:0xf bank_mask:0xf
  v_add_f32_dpp v30, v30, v30 row_half_mirror row_mask:0xf bank_mask:0xf
  v_add_f32_dpp v31, v31, v31 row_half_mirror row_mask:0xf bank_mask:0xf
  v_add_f32_dpp v32, v32, v32 row_half_mirror row_mask:0xf bank_mask:0xf
  v_add_f32_dpp v33, v33, v33 row_half_mirror row_mask:0xf bank_mask:0xf
  v_add_f32_dpp v34, v34, v34 row_half_mirror row_mask:0xf bank_mask:0xf
  v_add_f32_dpp v35, v35, v35 row_half_mirror row_mask:0xf bank_mask:0xf
  v_add_f32_dpp v36, v36, v36 row_half_mirror row_mask:0xf bank_mask:0xf
  v_add_f32_dpp v37, v37, v37 row_half_mirror row_mask:0xf bank_mask:0xf
  v_add_f32_dpp v38, v38, v38 row_half_mirror row_mask:0xf bank_mask:0xf
  v_add_f32_dpp v39, v39, v39 row_half_mirror row_mask:0xf bank_mask:0xf
  v_add_f32_dpp v40, v40, v40 row_half_mirror row_mask:0xf bank_mask:0xf
  v_add_f32_dpp v41, v41, v41 row_half_mirror row_mask:0xf bank_mask:0xf
  v_add_f32_dpp v42, v42, v42 row_half_mirror row_mask:0xf bank_mask:0xf
  v_add_f32_dpp v43, v43, v43 row_half_mirror row_mask:0xf bank_mask:0xf
  v_add_f32_dpp v44, v44, v44 row_half_mirror row_mask:0xf bank_mask:0xf
  v_add_f32_dpp v45, v45, v45 row_half_mirror row_mask:0xf bank_mask:0xf
  v_add_f32_dpp v46, v46, v46 row_half_mirror row_mask:0xf bank_mask:0xf
  v_add_f32_dpp v47, v47, v47 row_half_mirror row_mask:0xf bank_mask:0xf
  v_add_f32_dpp v48, v48, v48 row_half_mirror row_mask:0xf bank_mask:0xf
  v_add_f32_dpp v49, v49, v49 row_half_mirror row_mask:0xf bank_mask:0xf
  v_add_f32_dpp v50, v50, v50 row_half_mirror row_mask:0xf bank_mask:0xf
  v_add_f32_dpp v51, v51, v51 row_half_mirror row_mask:0xf bank_mask:0xf
  v_add_f32_dpp v52, v52, v52 row_half_mirror row_mask:0xf bank_mask:0xf
  v_add_f32_dpp v53, v53, v53 row_half_mirror row_mask:0xf bank_mask:0xf
  v_add_f32_dpp v54, v54, v54 row_half_mirror row_mask:0xf bank_mask:0xf
  v_add_f32_dpp v55, v55, v55 row_half_mirror row_mask:0xf bank_mask:0xf
  v_add_f32_dpp v56, v56, v56 row_half_mirror row_mask:0xf bank_mask:0xf
  v_add_f32_dpp v57, v57, v57 row_half_mirror row_mask:0xf bank_mask:0xf
  v_add_f32_dpp v58, v58, v58 row_half_mirror row_mask:0xf bank_mask:0xf
  v_add_f32_dpp v59, v59, v59 row_half_mirror row_mask:0xf bank_mask:0xf
  s_mov_b32 s25, 0x3dd53b95
  v_mul_f32 v28, s25, v28
  v_mul_f32 v29, s25, v29
  v_mul_f32 v30, s25, v30
  v_mul_f32 v31, s25, v31
  v_mul_f32 v32, s25, v32
  v_mul_f32 v33, s25, v33
  v_mul_f32 v34, s25, v34
  v_mul_f32 v35, s25, v35
  v_mul_f32 v36, s25, v36
  v_mul_f32 v37, s25, v37
  v_mul_f32 v38, s25, v38
  v_mul_f32 v39, s25, v39
  v_mul_f32 v40, s25, v40
  v_mul_f32 v41, s25, v41
  v_mul_f32 v42, s25, v42
  v_mul_f32 v43, s25, v43
  v_mul_f32 v44, s25, v44
  v_mul_f32 v45, s25, v45
  v_mul_f32 v46, s25, v46
  v_mul_f32 v47, s25, v47
  v_mul_f32 v48, s25, v48
  v_mul_f32 v49, s25, v49
  v_mul_f32 v50, s25, v50
  v_mul_f32 v51, s25, v51
  v_mul_f32 v52, s25, v52
  v_mul_f32 v53, s25, v53
  v_mul_f32 v54, s25, v54
  v_mul_f32 v55, s25, v55
  v_mul_f32 v56, s25, v56
  v_mul_f32 v57, s25, v57
  v_mul_f32 v58, s25, v58
  v_mul_f32 v59, s25, v59
  v_max3_f32 v121, v28, v29, v30
  v_max3_f32 v121, v121, v31, v32
  v_max3_f32 v121, v121, v33, v34
  v_max3_f32 v121, v121, v35, v36
  v_max3_f32 v121, v121, v37, v38
  v_max3_f32 v121, v121, v39, v40
  v_max3_f32 v121, v121, v41, v42
  v_max3_f32 v121, v121, v43, v44
  v_max3_f32 v121, v121, v45, v46
  v_max3_f32 v121, v121, v47, v48
  v_max3_f32 v121, v121, v49, v50
  v_max3_f32 v121, v121, v51, v52
  v_max3_f32 v121, v121, v53, v54
  v_max3_f32 v121, v121, v55, v56
  v_max3_f32 v121, v121, v57, v58
  v_max_f32 v121, v121, v59
  v_sub_f32 v28, v28, v121
  v_sub_f32 v29, v29, v121
  v_sub_f32 v30, v30, v121
  v_sub_f32 v31, v31, v121
  v_sub_f32 v32, v32, v121
  v_sub_f32 v33, v33, v121
  v_sub_f32 v34, v34, v121
  v_sub_f32 v35, v35, v121
  v_sub_f32 v36, v36, v121
  v_sub_f32 v37, v37, v121
  v_sub_f32 v38, v38, v121
  v_sub_f32 v39, v39, v121
  v_sub_f32 v40, v40, v121
  v_sub_f32 v41, v41, v121
  v_sub_f32 v42, v42, v121
  v_sub_f32 v43, v43, v121
  v_sub_f32 v44, v44, v121
  v_sub_f32 v45, v45, v121
  v_sub_f32 v46, v46, v121
  v_sub_f32 v47, v47, v121
  v_sub_f32 v48, v48, v121
  v_sub_f32 v49, v49, v121
  v_sub_f32 v50, v50, v121
  v_sub_f32 v51, v51, v121
  v_sub_f32 v52, v52, v121
  v_sub_f32 v53, v53, v121
  v_sub_f32 v54, v54, v121
  v_sub_f32 v55, v55, v121
  v_sub_f32 v56, v56, v121
  v_sub_f32 v57, v57, v121
  v_sub_f32 v58, v58, v121
  v_sub_f32 v59, v59, v121
  v_exp_f32 v28, v28
  v_exp_f32 v29, v29
  v_exp_f32 v30, v30
  v_exp_f32 v31, v31
  v_exp_f32 v32, v32
  v_exp_f32 v33, v33
  v_exp_f32 v34, v34
  v_exp_f32 v35, v35
  v_exp_f32 v36, v36
  v_exp_f32 v37, v37
  v_exp_f32 v38, v38
  v_exp_f32 v39, v39
  v_exp_f32 v40, v40
  v_exp_f32 v41, v41
  v_exp_f32 v42, v42
  v_exp_f32 v43, v43
  v_exp_f32 v44, v44
  v_exp_f32 v45, v45
  v_exp_f32 v46, v46
  v_exp_f32 v47, v47
  v_exp_f32 v48, v48
  v_exp_f32 v49, v49
  v_exp_f32 v50, v50
  v_exp_f32 v51, v51
  v_exp_f32 v52, v52
  v_exp_f32 v53, v53
  v_exp_f32 v54, v54
  v_exp_f32 v55, v55
  v_exp_f32 v56, v56
  v_exp_f32 v57, v57
  v_exp_f32 v58, v58
  v_exp_f32 v59, v59
  s_nop 0
  v_add_f32 v122, v28, v29
  v_add_f32 v122, v122, v30
  v_add_f32 v122, v122, v31
  v_add_f32 v122, v122, v32
  v_add_f32 v122, v122, v33
  v_add_f32 v122, v122, v34
  v_add_f32 v122, v122, v35
  v_add_f32 v122, v122, v36
  v_add_f32 v122, v122, v37
  v_add_f32 v122, v122, v38
  v_add_f32 v122, v122, v39
  v_add_f32 v122, v122, v40
  v_add_f32 v122, v122, v41
  v_add_f32 v122, v122, v42
  v_add_f32 v122, v122, v43
  v_add_f32 v122, v122, v44
  v_add_f32 v122, v122, v45
  v_add_f32 v122, v122, v46
  v_add_f32 v122, v122, v47
  v_add_f32 v122, v122, v48
  v_add_f32 v122, v122, v49
  v_add_f32 v122, v122, v50
  v_add_f32 v122, v122, v51
  v_add_f32 v122, v122, v52
  v_add_f32 v122, v122, v53
  v_add_f32 v122, v122, v54
  v_add_f32 v122, v122, v55
  v_add_f32 v122, v122, v56
  v_add_f32 v122, v122, v57
  v_add_f32 v122, v122, v58
  v_add_f32 v122, v122, v59
  v_mov_b32 v4, 0
  v_mov_b32 v5, 0
  v_mov_b32 v6, 0
  v_mov_b32 v7, 0
  v_mov_b32 v8, 0
  v_mov_b32 v9, 0
  v_mov_b32 v10, 0
  v_mov_b32 v11, 0
  v_mov_b32 v12, 0
  v_mov_b32 v13, 0
  v_mov_b32 v14, 0
  v_mov_b32 v15, 0
  v_mov_b32 v16, 0
  v_mov_b32 v17, 0
  v_mov_b32 v18, 0
  v_mov_b32 v19, 0
  v_mov_b32 v20, 0
  v_mov_b32 v21, 0
  v_mov_b32 v22, 0
  v_mov_b32 v23, 0
  v_mov_b32 v24, 0
  v_mov_b32 v25, 0
  v_mov_b32 v26, 0
  v_mov_b32 v27, 0
  buffer_load_dwordx4 v[72:75], v1, s[12:15], s24 offen offset:0 nt
  buffer_load_dwordx4 v[76:79], v1, s[12:15], s24 offen offset:128 nt
  buffer_load_dwordx4 v[80:83], v1, s[12:15], s24 offen offset:256 nt
  s_add_u32 s24, s24, 3072
  s_waitcnt vmcnt(12)
  v_lshlrev_b32 v123, 16, v84
  v_and_b32 v124, 0xffff0000, v84
  v_fmac_f32 v4, v28, v123
  v_fmac_f32 v5, v28, v124
  v_lshlrev_b32 v125, 16, v85
  v_and_b32 v126, 0xffff0000, v85
  v_fmac_f32 v6, v28, v125
  v_fmac_f32 v7, v28, v126
  v_lshlrev_b32 v123, 16, v86
  v_and_b32 v124, 0xffff0000, v86
  v_fmac_f32 v8, v28, v123
  v_fmac_f32 v9, v28, v124
  v_lshlrev_b32 v125, 16, v87
  v_and_b32 v126, 0xffff0000, v87
  v_fmac_f32 v10, v28, v125
  v_fmac_f32 v11, v28, v126
  v_lshlrev_b32 v123, 16, v88
  v_and_b32 v124, 0xffff0000, v88
  v_fmac_f32 v12, v28, v123
  v_fmac_f32 v13, v28, v124
  v_lshlrev_b32 v125, 16, v89
  v_and_b32 v126, 0xffff0000, v89
  v_fmac_f32 v14, v28, v125
  v_fmac_f32 v15, v28, v126
  v_lshlrev_b32 v123, 16, v90
  v_and_b32 v124, 0xffff0000, v90
  v_fmac_f32 v16, v28, v123
  v_fmac_f32 v17, v28, v124
  v_lshlrev_b32 v125, 16, v91
  v_and_b32 v126, 0xffff0000, v91
  v_fmac_f32 v18, v28, v125
  v_fmac_f32 v19, v28, v126
  v_lshlrev_b32 v123, 16, v92
  v_and_b32 v124, 0xffff0000, v92
  v_fmac_f32 v20, v28, v123
  v_fmac_f32 v21, v28, v124
  v_lshlrev_b32 v125, 16, v93
  v_and_b32 v126, 0xffff0000, v93
  v_fmac_f32 v22, v28, v125
  v_fmac_f32 v23, v28, v126
  v_lshlrev_b32 v123, 16, v94
  v_and_b32 v124, 0xffff0000, v94
  v_fmac_f32 v24, v28, v123
  v_fmac_f32 v25, v28, v124
  v_lshlrev_b32 v125, 16, v95
  v_and_b32 v126, 0xffff0000, v95
  v_fmac_f32 v26, v28, v125
  v_fmac_f32 v27, v28, v126
  buffer_load_dwordx4 v[84:87], v1, s[12:15], s24 offen offset:0 nt
  buffer_load_dwordx4 v[88:91], v1, s[12:15], s24 offen offset:128 nt
  buffer_load_dwordx4 v[92:95], v1, s[12:15], s24 offen offset:256 nt
  s_add_u32 s24, s24, 3072
  s_waitcnt vmcnt(12)
  v_lshlrev_b32 v123, 16, v96
  v_and_b32 v124, 0xffff0000, v96
  v_fmac_f32 v4, v29, v123
  v_fmac_f32 v5, v29, v124
  v_lshlrev_b32 v125, 16, v97
  v_and_b32 v126, 0xffff0000, v97
  v_fmac_f32 v6, v29, v125
  v_fmac_f32 v7, v29, v126
  v_lshlrev_b32 v123, 16, v98
  v_and_b32 v124, 0xffff0000, v98
  v_fmac_f32 v8, v29, v123
  v_fmac_f32 v9, v29, v124
  v_lshlrev_b32 v125, 16, v99
  v_and_b32 v126, 0xffff0000, v99
  v_fmac_f32 v10, v29, v125
  v_fmac_f32 v11, v29, v126
  v_lshlrev_b32 v123, 16, v100
  v_and_b32 v124, 0xffff0000, v100
  v_fmac_f32 v12, v29, v123
  v_fmac_f32 v13, v29, v124
  v_lshlrev_b32 v125, 16, v101
  v_and_b32 v126, 0xffff0000, v101
  v_fmac_f32 v14, v29, v125
  v_fmac_f32 v15, v29, v126
  v_lshlrev_b32 v123, 16, v102
  v_and_b32 v124, 0xffff0000, v102
  v_fmac_f32 v16, v29, v123
  v_fmac_f32 v17, v29, v124
  v_lshlrev_b32 v125, 16, v103
  v_and_b32 v126, 0xffff0000, v103
  v_fmac_f32 v18, v29, v125
  v_fmac_f32 v19, v29, v126
  v_lshlrev_b32 v123, 16, v104
  v_and_b32 v124, 0xffff0000, v104
  v_fmac_f32 v20, v29, v123
  v_fmac_f32 v21, v29, v124
  v_lshlrev_b32 v125, 16, v105
  v_and_b32 v126, 0xffff0000, v105
  v_fmac_f32 v22, v29, v125
  v_fmac_f32 v23, v29, v126
  v_lshlrev_b32 v123, 16, v106
  v_and_b32 v124, 0xffff0000, v106
  v_fmac_f32 v24, v29, v123
  v_fmac_f32 v25, v29, v124
  v_lshlrev_b32 v125, 16, v107
  v_and_b32 v126, 0xffff0000, v107
  v_fmac_f32 v26, v29, v125
  v_fmac_f32 v27, v29, v126
  buffer_load_dwordx4 v[96:99], v1, s[12:15], s24 offen offset:0 nt
  buffer_load_dwordx4 v[100:103], v1, s[12:15], s24 offen offset:128 nt
  buffer_load_dwordx4 v[104:107], v1, s[12:15], s24 offen offset:256 nt
  s_add_u32 s24, s24, 3072
  s_waitcnt vmcnt(12)
  v_lshlrev_b32 v123, 16, v108
  v_and_b32 v124, 0xffff0000, v108
  v_fmac_f32 v4, v30, v123
  v_fmac_f32 v5, v30, v124
  v_lshlrev_b32 v125, 16, v109
  v_and_b32 v126, 0xffff0000, v109
  v_fmac_f32 v6, v30, v125
  v_fmac_f32 v7, v30, v126
  v_lshlrev_b32 v123, 16, v110
  v_and_b32 v124, 0xffff0000, v110
  v_fmac_f32 v8, v30, v123
  v_fmac_f32 v9, v30, v124
  v_lshlrev_b32 v125, 16, v111
  v_and_b32 v126, 0xffff0000, v111
  v_fmac_f32 v10, v30, v125
  v_fmac_f32 v11, v30, v126
  v_lshlrev_b32 v123, 16, v112
  v_and_b32 v124, 0xffff0000, v112
  v_fmac_f32 v12, v30, v123
  v_fmac_f32 v13, v30, v124
  v_lshlrev_b32 v125, 16, v113
  v_and_b32 v126, 0xffff0000, v113
  v_fmac_f32 v14, v30, v125
  v_fmac_f32 v15, v30, v126
  v_lshlrev_b32 v123, 16, v114
  v_and_b32 v124, 0xffff0000, v114
  v_fmac_f32 v16, v30, v123
  v_fmac_f32 v17, v30, v124
  v_lshlrev_b32 v125, 16, v115
  v_and_b32 v126, 0xffff0000, v115
  v_fmac_f32 v18, v30, v125
  v_fmac_f32 v19, v30, v126
  v_lshlrev_b32 v123, 16, v116
  v_and_b32 v124, 0xffff0000, v116
  v_fmac_f32 v20, v30, v123
  v_fmac_f32 v21, v30, v124
  v_lshlrev_b32 v125, 16, v117
  v_and_b32 v126, 0xffff0000, v117
  v_fmac_f32 v22, v30, v125
  v_fmac_f32 v23, v30, v126
  v_lshlrev_b32 v123, 16, v118
  v_and_b32 v124, 0xffff0000, v118
  v_fmac_f32 v24, v30, v123
  v_fmac_f32 v25, v30, v124
  v_lshlrev_b32 v125, 16, v119
  v_and_b32 v126, 0xffff0000, v119
  v_fmac_f32 v26, v30, v125
  v_fmac_f32 v27, v30, v126
  buffer_load_dwordx4 v[108:111], v1, s[12:15], s24 offen offset:0 nt
  buffer_load_dwordx4 v[112:115], v1, s[12:15], s24 offen offset:128 nt
  buffer_load_dwordx4 v[116:119], v1, s[12:15], s24 offen offset:256 nt
  s_add_u32 s24, s24, 3072
  s_waitcnt vmcnt(12)
  v_lshlrev_b32 v123, 16, v60
  v_and_b32 v124, 0xffff0000, v60
  v_fmac_f32 v4, v31, v123
  v_fmac_f32 v5, v31, v124
  v_lshlrev_b32 v125, 16, v61
  v_and_b32 v126, 0xffff0000, v61
  v_fmac_f32 v6, v31, v125
  v_fmac_f32 v7, v31, v126
  v_lshlrev_b32 v123, 16, v62
  v_and_b32 v124, 0xffff0000, v62
  v_fmac_f32 v8, v31, v123
  v_fmac_f32 v9, v31, v124
  v_lshlrev_b32 v125, 16, v63
  v_and_b32 v126, 0xffff0000, v63
  v_fmac_f32 v10, v31, v125
  v_fmac_f32 v11, v31, v126
  v_lshlrev_b32 v123, 16, v64
  v_and_b32 v124, 0xffff0000, v64
  v_fmac_f32 v12, v31, v123
  v_fmac_f32 v13, v31, v124
  v_lshlrev_b32 v125, 16, v65
  v_and_b32 v126, 0xffff0000, v65
  v_fmac_f32 v14, v31, v125
  v_fmac_f32 v15, v31, v126
  v_lshlrev_b32 v123, 16, v66
  v_and_b32 v124, 0xffff0000, v66
  v_fmac_f32 v16, v31, v123
  v_fmac_f32 v17, v31, v124
  v_lshlrev_b32 v125, 16, v67
  v_and_b32 v126, 0xffff0000, v67
  v_fmac_f32 v18, v31, v125
  v_fmac_f32 v19, v31, v126
  v_lshlrev_b32 v123, 16, v68
  v_and_b32 v124, 0xffff0000, v68
  v_fmac_f32 v20, v31, v123
  v_fmac_f32 v21, v31, v124
  v_lshlrev_b32 v125, 16, v69
  v_and_b32 v126, 0xffff0000, v69
  v_fmac_f32 v22, v31, v125
  v_fmac_f32 v23, v31, v126
  v_lshlrev_b32 v123, 16, v70
  v_and_b32 v124, 0xffff0000, v70
  v_fmac_f32 v24, v31, v123
  v_fmac_f32 v25, v31, v124
  v_lshlrev_b32 v125, 16, v71
  v_and_b32 v126, 0xffff0000, v71
  v_fmac_f32 v26, v31, v125
  v_fmac_f32 v27, v31, v126
  buffer_load_dwordx4 v[60:63], v1, s[12:15], s24 offen offset:0 nt
  buffer_load_dwordx4 v[64:67], v1, s[12:15], s24 offen offset:128 nt
  buffer_load_dwordx4 v[68:71], v1, s[12:15], s24 offen offset:256 nt
  s_add_u32 s24, s24, 3072
  s_waitcnt vmcnt(12)
  v_lshlrev_b32 v123, 16, v72
  v_and_b32 v124, 0xffff0000, v72
  v_fmac_f32 v4, v32, v123
  v_fmac_f32 v5, v32, v124
  v_lshlrev_b32 v125, 16, v73
  v_and_b32 v126, 0xffff0000, v73
  v_fmac_f32 v6, v32, v125
  v_fmac_f32 v7, v32, v126
  v_lshlrev_b32 v123, 16, v74
  v_and_b32 v124, 0xffff0000, v74
  v_fmac_f32 v8, v32, v123
  v_fmac_f32 v9, v32, v124
  v_lshlrev_b32 v125, 16, v75
  v_and_b32 v126, 0xffff0000, v75
  v_fmac_f32 v10, v32, v125
  v_fmac_f32 v11, v32, v126
  v_lshlrev_b32 v123, 16, v76
  v_and_b32 v124, 0xffff0000, v76
  v_fmac_f32 v12, v32, v123
  v_fmac_f32 v13, v32, v124
  v_lshlrev_b32 v125, 16, v77
  v_and_b32 v126, 0xffff0000, v77
  v_fmac_f32 v14, v32, v125
  v_fmac_f32 v15, v32, v126
  v_lshlrev_b32 v123, 16, v78
  v_and_b32 v124, 0xffff0000, v78
  v_fmac_f32 v16, v32, v123
  v_fmac_f32 v17, v32, v124
  v_lshlrev_b32 v125, 16, v79
  v_and_b32 v126, 0xffff0000, v79
  v_fmac_f32 v18, v32, v125
  v_fmac_f32 v19, v32, v126
  v_lshlrev_b32 v123, 16, v80
  v_and_b32 v124, 0xffff0000, v80
  v_fmac_f32 v20, v32, v123
  v_fmac_f32 v21, v32, v124
  v_lshlrev_b32 v125, 16, v81
  v_and_b32 v126, 0xffff0000, v81
  v_fmac_f32 v22, v32, v125
  v_fmac_f32 v23, v32, v126
  v_lshlrev_b32 v123, 16, v82
  v_and_b32 v124, 0xffff0000, v82
  v_fmac_f32 v24, v32, v123
  v_fmac_f32 v25, v32, v124
  v_lshlrev_b32 v125, 16, v83
  v_and_b32 v126, 0xffff0000, v83
  v_fmac_f32 v26, v32, v125
  v_fmac_f32 v27, v32, v126
  buffer_load_dwordx4 v[72:75], v1, s[12:15], s24 offen offset:0 nt
  buffer_load_dwordx4 v[76:79], v1, s[12:15], s24 offen offset:128 nt
  buffer_load_dwordx4 v[80:83], v1, s[12:15], s24 offen offset:256 nt
  s_add_u32 s24, s24, 3072
  s_waitcnt vmcnt(12)
  v_lshlrev_b32 v123, 16, v84
  v_and_b32 v124, 0xffff0000, v84
  v_fmac_f32 v4, v33, v123
  v_fmac_f32 v5, v33, v124
  v_lshlrev_b32 v125, 16, v85
  v_and_b32 v126, 0xffff0000, v85
  v_fmac_f32 v6, v33, v125
  v_fmac_f32 v7, v33, v126
  v_lshlrev_b32 v123, 16, v86
  v_and_b32 v124, 0xffff0000, v86
  v_fmac_f32 v8, v33, v123
  v_fmac_f32 v9, v33, v124
  v_lshlrev_b32 v125, 16, v87
  v_and_b32 v126, 0xffff0000, v87
  v_fmac_f32 v10, v33, v125
  v_fmac_f32 v11, v33, v126
  v_lshlrev_b32 v123, 16, v88
  v_and_b32 v124, 0xffff0000, v88
  v_fmac_f32 v12, v33, v123
  v_fmac_f32 v13, v33, v124
  v_lshlrev_b32 v125, 16, v89
  v_and_b32 v126, 0xffff0000, v89
  v_fmac_f32 v14, v33, v125
  v_fmac_f32 v15, v33, v126
  v_lshlrev_b32 v123, 16, v90
  v_and_b32 v124, 0xffff0000, v90
  v_fmac_f32 v16, v33, v123
  v_fmac_f32 v17, v33, v124
  v_lshlrev_b32 v125, 16, v91
  v_and_b32 v126, 0xffff0000, v91
  v_fmac_f32 v18, v33, v125
  v_fmac_f32 v19, v33, v126
  v_lshlrev_b32 v123, 16, v92
  v_and_b32 v124, 0xffff0000, v92
  v_fmac_f32 v20, v33, v123
  v_fmac_f32 v21, v33, v124
  v_lshlrev_b32 v125, 16, v93
  v_and_b32 v126, 0xffff0000, v93
  v_fmac_f32 v22, v33, v125
  v_fmac_f32 v23, v33, v126
  v_lshlrev_b32 v123, 16, v94
  v_and_b32 v124, 0xffff0000, v94
  v_fmac_f32 v24, v33, v123
  v_fmac_f32 v25, v33, v124
  v_lshlrev_b32 v125, 16, v95
  v_and_b32 v126, 0xffff0000, v95
  v_fmac_f32 v26, v33, v125
  v_fmac_f32 v27, v33, v126
  buffer_load_dwordx4 v[84:87], v1, s[12:15], s24 offen offset:0 nt
  buffer_load_dwordx4 v[88:91], v1, s[12:15], s24 offen offset:128 nt
  buffer_load_dwordx4 v[92:95], v1, s[12:15], s24 offen offset:256 nt
  s_add_u32 s24, s24, 3072
  s_waitcnt vmcnt(12)
  v_lshlrev_b32 v123, 16, v96
  v_and_b32 v124, 0xffff0000, v96
  v_fmac_f32 v4, v34, v123
  v_fmac_f32 v5, v34, v124
  v_lshlrev_b32 v125, 16, v97
  v_and_b32 v126, 0xffff0000, v97
  v_fmac_f32 v6, v34, v125
  v_fmac_f32 v7, v34, v126
  v_lshlrev_b32 v123, 16, v98
  v_and_b32 v124, 0xffff0000, v98
  v_fmac_f32 v8, v34, v123
  v_fmac_f32 v9, v34, v124
  v_lshlrev_b32 v125, 16, v99
  v_and_b32 v126, 0xffff0000, v99
  v_fmac_f32 v10, v34, v125
  v_fmac_f32 v11, v34, v126
  v_lshlrev_b32 v123, 16, v100
  v_and_b32 v124, 0xffff0000, v100
  v_fmac_f32 v12, v34, v123
  v_fmac_f32 v13, v34, v124
  v_lshlrev_b32 v125, 16, v101
  v_and_b32 v126, 0xffff0000, v101
  v_fmac_f32 v14, v34, v125
  v_fmac_f32 v15, v34, v126
  v_lshlrev_b32 v123, 16, v102
  v_and_b32 v124, 0xffff0000, v102
  v_fmac_f32 v16, v34, v123
  v_fmac_f32 v17, v34, v124
  v_lshlrev_b32 v125, 16, v103
  v_and_b32 v126, 0xffff0000, v103
  v_fmac_f32 v18, v34, v125
  v_fmac_f32 v19, v34, v126
  v_lshlrev_b32 v123, 16, v104
  v_and_b32 v124, 0xffff0000, v104
  v_fmac_f32 v20, v34, v123
  v_fmac_f32 v21, v34, v124
  v_lshlrev_b32 v125, 16, v105
  v_and_b32 v126, 0xffff0000, v105
  v_fmac_f32 v22, v34, v125
  v_fmac_f32 v23, v34, v126
  v_lshlrev_b32 v123, 16, v106
  v_and_b32 v124, 0xffff0000, v106
  v_fmac_f32 v24, v34, v123
  v_fmac_f32 v25, v34, v124
  v_lshlrev_b32 v125, 16, v107
  v_and_b32 v126, 0xffff0000, v107
  v_fmac_f32 v26, v34, v125
  v_fmac_f32 v27, v34, v126
  buffer_load_dwordx4 v[96:99], v1, s[12:15], s24 offen offset:0 nt
  buffer_load_dwordx4 v[100:103], v1, s[12:15], s24 offen offset:128 nt
  buffer_load_dwordx4 v[104:107], v1, s[12:15], s24 offen offset:256 nt
  s_add_u32 s24, s24, 3072
  s_waitcnt vmcnt(12)
  v_lshlrev_b32 v123, 16, v108
  v_and_b32 v124, 0xffff0000, v108
  v_fmac_f32 v4, v35, v123
  v_fmac_f32 v5, v35, v124
  v_lshlrev_b32 v125, 16, v109
  v_and_b32 v126, 0xffff0000, v109
  v_fmac_f32 v6, v35, v125
  v_fmac_f32 v7, v35, v126
  v_lshlrev_b32 v123, 16, v110
  v_and_b32 v124, 0xffff0000, v110
  v_fmac_f32 v8, v35, v123
  v_fmac_f32 v9, v35, v124
  v_lshlrev_b32 v125, 16, v111
  v_and_b32 v126, 0xffff0000, v111
  v_fmac_f32 v10, v35, v125
  v_fmac_f32 v11, v35, v126
  v_lshlrev_b32 v123, 16, v112
  v_and_b32 v124, 0xffff0000, v112
  v_fmac_f32 v12, v35, v123
  v_fmac_f32 v13, v35, v124
  v_lshlrev_b32 v125, 16, v113
  v_and_b32 v126, 0xffff0000, v113
  v_fmac_f32 v14, v35, v125
  v_fmac_f32 v15, v35, v126
  v_lshlrev_b32 v123, 16, v114
  v_and_b32 v124, 0xffff0000, v114
  v_fmac_f32 v16, v35, v123
  v_fmac_f32 v17, v35, v124
  v_lshlrev_b32 v125, 16, v115
  v_and_b32 v126, 0xffff0000, v115
  v_fmac_f32 v18, v35, v125
  v_fmac_f32 v19, v35, v126
  v_lshlrev_b32 v123, 16, v116
  v_and_b32 v124, 0xffff0000, v116
  v_fmac_f32 v20, v35, v123
  v_fmac_f32 v21, v35, v124
  v_lshlrev_b32 v125, 16, v117
  v_and_b32 v126, 0xffff0000, v117
  v_fmac_f32 v22, v35, v125
  v_fmac_f32 v23, v35, v126
  v_lshlrev_b32 v123, 16, v118
  v_and_b32 v124, 0xffff0000, v118
  v_fmac_f32 v24, v35, v123
  v_fmac_f32 v25, v35, v124
  v_lshlrev_b32 v125, 16, v119
  v_and_b32 v126, 0xffff0000, v119
  v_fmac_f32 v26, v35, v125
  v_fmac_f32 v27, v35, v126
  buffer_load_dwordx4 v[108:111], v1, s[12:15], s24 offen offset:0 nt
  buffer_load_dwordx4 v[112:115], v1, s[12:15], s24 offen offset:128 nt
  buffer_load_dwordx4 v[116:119], v1, s[12:15], s24 offen offset:256 nt
  s_add_u32 s24, s24, 3072
  s_waitcnt vmcnt(12)
  v_lshlrev_b32 v123, 16, v60
  v_and_b32 v124, 0xffff0000, v60
  v_fmac_f32 v4, v36, v123
  v_fmac_f32 v5, v36, v124
  v_lshlrev_b32 v125, 16, v61
  v_and_b32 v126, 0xffff0000, v61
  v_fmac_f32 v6, v36, v125
  v_fmac_f32 v7, v36, v126
  v_lshlrev_b32 v123, 16, v62
  v_and_b32 v124, 0xffff0000, v62
  v_fmac_f32 v8, v36, v123
  v_fmac_f32 v9, v36, v124
  v_lshlrev_b32 v125, 16, v63
  v_and_b32 v126, 0xffff0000, v63
  v_fmac_f32 v10, v36, v125
  v_fmac_f32 v11, v36, v126
  v_lshlrev_b32 v123, 16, v64
  v_and_b32 v124, 0xffff0000, v64
  v_fmac_f32 v12, v36, v123
  v_fmac_f32 v13, v36, v124
  v_lshlrev_b32 v125, 16, v65
  v_and_b32 v126, 0xffff0000, v65
  v_fmac_f32 v14, v36, v125
  v_fmac_f32 v15, v36, v126
  v_lshlrev_b32 v123, 16, v66
  v_and_b32 v124, 0xffff0000, v66
  v_fmac_f32 v16, v36, v123
  v_fmac_f32 v17, v36, v124
  v_lshlrev_b32 v125, 16, v67
  v_and_b32 v126, 0xffff0000, v67
  v_fmac_f32 v18, v36, v125
  v_fmac_f32 v19, v36, v126
  v_lshlrev_b32 v123, 16, v68
  v_and_b32 v124, 0xffff0000, v68
  v_fmac_f32 v20, v36, v123
  v_fmac_f32 v21, v36, v124
  v_lshlrev_b32 v125, 16, v69
  v_and_b32 v126, 0xffff0000, v69
  v_fmac_f32 v22, v36, v125
  v_fmac_f32 v23, v36, v126
  v_lshlrev_b32 v123, 16, v70
  v_and_b32 v124, 0xffff0000, v70
  v_fmac_f32 v24, v36, v123
  v_fmac_f32 v25, v36, v124
  v_lshlrev_b32 v125, 16, v71
  v_and_b32 v126, 0xffff0000, v71
  v_fmac_f32 v26, v36, v125
  v_fmac_f32 v27, v36, v126
  buffer_load_dwordx4 v[60:63], v1, s[12:15], s24 offen offset:0 nt
  buffer_load_dwordx4 v[64:67], v1, s[12:15], s24 offen offset:128 nt
  buffer_load_dwordx4 v[68:71], v1, s[12:15], s24 offen offset:256 nt
  s_add_u32 s24, s24, 3072
  s_waitcnt vmcnt(12)
  v_lshlrev_b32 v123, 16, v72
  v_and_b32 v124, 0xffff0000, v72
  v_fmac_f32 v4, v37, v123
  v_fmac_f32 v5, v37, v124
  v_lshlrev_b32 v125, 16, v73
  v_and_b32 v126, 0xffff0000, v73
  v_fmac_f32 v6, v37, v125
  v_fmac_f32 v7, v37, v126
  v_lshlrev_b32 v123, 16, v74
  v_and_b32 v124, 0xffff0000, v74
  v_fmac_f32 v8, v37, v123
  v_fmac_f32 v9, v37, v124
  v_lshlrev_b32 v125, 16, v75
  v_and_b32 v126, 0xffff0000, v75
  v_fmac_f32 v10, v37, v125
  v_fmac_f32 v11, v37, v126
  v_lshlrev_b32 v123, 16, v76
  v_and_b32 v124, 0xffff0000, v76
  v_fmac_f32 v12, v37, v123
  v_fmac_f32 v13, v37, v124
  v_lshlrev_b32 v125, 16, v77
  v_and_b32 v126, 0xffff0000, v77
  v_fmac_f32 v14, v37, v125
  v_fmac_f32 v15, v37, v126
  v_lshlrev_b32 v123, 16, v78
  v_and_b32 v124, 0xffff0000, v78
  v_fmac_f32 v16, v37, v123
  v_fmac_f32 v17, v37, v124
  v_lshlrev_b32 v125, 16, v79
  v_and_b32 v126, 0xffff0000, v79
  v_fmac_f32 v18, v37, v125
  v_fmac_f32 v19, v37, v126
  v_lshlrev_b32 v123, 16, v80
  v_and_b32 v124, 0xffff0000, v80
  v_fmac_f32 v20, v37, v123
  v_fmac_f32 v21, v37, v124
  v_lshlrev_b32 v125, 16, v81
  v_and_b32 v126, 0xffff0000, v81
  v_fmac_f32 v22, v37, v125
  v_fmac_f32 v23, v37, v126
  v_lshlrev_b32 v123, 16, v82
  v_and_b32 v124, 0xffff0000, v82
  v_fmac_f32 v24, v37, v123
  v_fmac_f32 v25, v37, v124
  v_lshlrev_b32 v125, 16, v83
  v_and_b32 v126, 0xffff0000, v83
  v_fmac_f32 v26, v37, v125
  v_fmac_f32 v27, v37, v126
  buffer_load_dwordx4 v[72:75], v1, s[12:15], s24 offen offset:0 nt
  buffer_load_dwordx4 v[76:79], v1, s[12:15], s24 offen offset:128 nt
  buffer_load_dwordx4 v[80:83], v1, s[12:15], s24 offen offset:256 nt
  s_add_u32 s24, s24, 3072
  s_waitcnt vmcnt(12)
  v_lshlrev_b32 v123, 16, v84
  v_and_b32 v124, 0xffff0000, v84
  v_fmac_f32 v4, v38, v123
  v_fmac_f32 v5, v38, v124
  v_lshlrev_b32 v125, 16, v85
  v_and_b32 v126, 0xffff0000, v85
  v_fmac_f32 v6, v38, v125
  v_fmac_f32 v7, v38, v126
  v_lshlrev_b32 v123, 16, v86
  v_and_b32 v124, 0xffff0000, v86
  v_fmac_f32 v8, v38, v123
  v_fmac_f32 v9, v38, v124
  v_lshlrev_b32 v125, 16, v87
  v_and_b32 v126, 0xffff0000, v87
  v_fmac_f32 v10, v38, v125
  v_fmac_f32 v11, v38, v126
  v_lshlrev_b32 v123, 16, v88
  v_and_b32 v124, 0xffff0000, v88
  v_fmac_f32 v12, v38, v123
  v_fmac_f32 v13, v38, v124
  v_lshlrev_b32 v125, 16, v89
  v_and_b32 v126, 0xffff0000, v89
  v_fmac_f32 v14, v38, v125
  v_fmac_f32 v15, v38, v126
  v_lshlrev_b32 v123, 16, v90
  v_and_b32 v124, 0xffff0000, v90
  v_fmac_f32 v16, v38, v123
  v_fmac_f32 v17, v38, v124
  v_lshlrev_b32 v125, 16, v91
  v_and_b32 v126, 0xffff0000, v91
  v_fmac_f32 v18, v38, v125
  v_fmac_f32 v19, v38, v126
  v_lshlrev_b32 v123, 16, v92
  v_and_b32 v124, 0xffff0000, v92
  v_fmac_f32 v20, v38, v123
  v_fmac_f32 v21, v38, v124
  v_lshlrev_b32 v125, 16, v93
  v_and_b32 v126, 0xffff0000, v93
  v_fmac_f32 v22, v38, v125
  v_fmac_f32 v23, v38, v126
  v_lshlrev_b32 v123, 16, v94
  v_and_b32 v124, 0xffff0000, v94
  v_fmac_f32 v24, v38, v123
  v_fmac_f32 v25, v38, v124
  v_lshlrev_b32 v125, 16, v95
  v_and_b32 v126, 0xffff0000, v95
  v_fmac_f32 v26, v38, v125
  v_fmac_f32 v27, v38, v126
  buffer_load_dwordx4 v[84:87], v1, s[12:15], s24 offen offset:0 nt
  buffer_load_dwordx4 v[88:91], v1, s[12:15], s24 offen offset:128 nt
  buffer_load_dwordx4 v[92:95], v1, s[12:15], s24 offen offset:256 nt
  s_add_u32 s24, s24, 3072
  s_waitcnt vmcnt(12)
  v_lshlrev_b32 v123, 16, v96
  v_and_b32 v124, 0xffff0000, v96
  v_fmac_f32 v4, v39, v123
  v_fmac_f32 v5, v39, v124
  v_lshlrev_b32 v125, 16, v97
  v_and_b32 v126, 0xffff0000, v97
  v_fmac_f32 v6, v39, v125
  v_fmac_f32 v7, v39, v126
  v_lshlrev_b32 v123, 16, v98
  v_and_b32 v124, 0xffff0000, v98
  v_fmac_f32 v8, v39, v123
  v_fmac_f32 v9, v39, v124
  v_lshlrev_b32 v125, 16, v99
  v_and_b32 v126, 0xffff0000, v99
  v_fmac_f32 v10, v39, v125
  v_fmac_f32 v11, v39, v126
  v_lshlrev_b32 v123, 16, v100
  v_and_b32 v124, 0xffff0000, v100
  v_fmac_f32 v12, v39, v123
  v_fmac_f32 v13, v39, v124
  v_lshlrev_b32 v125, 16, v101
  v_and_b32 v126, 0xffff0000, v101
  v_fmac_f32 v14, v39, v125
  v_fmac_f32 v15, v39, v126
  v_lshlrev_b32 v123, 16, v102
  v_and_b32 v124, 0xffff0000, v102
  v_fmac_f32 v16, v39, v123
  v_fmac_f32 v17, v39, v124
  v_lshlrev_b32 v125, 16, v103
  v_and_b32 v126, 0xffff0000, v103
  v_fmac_f32 v18, v39, v125
  v_fmac_f32 v19, v39, v126
  v_lshlrev_b32 v123, 16, v104
  v_and_b32 v124, 0xffff0000, v104
  v_fmac_f32 v20, v39, v123
  v_fmac_f32 v21, v39, v124
  v_lshlrev_b32 v125, 16, v105
  v_and_b32 v126, 0xffff0000, v105
  v_fmac_f32 v22, v39, v125
  v_fmac_f32 v23, v39, v126
  v_lshlrev_b32 v123, 16, v106
  v_and_b32 v124, 0xffff0000, v106
  v_fmac_f32 v24, v39, v123
  v_fmac_f32 v25, v39, v124
  v_lshlrev_b32 v125, 16, v107
  v_and_b32 v126, 0xffff0000, v107
  v_fmac_f32 v26, v39, v125
  v_fmac_f32 v27, v39, v126
  buffer_load_dwordx4 v[96:99], v1, s[12:15], s24 offen offset:0 nt
  buffer_load_dwordx4 v[100:103], v1, s[12:15], s24 offen offset:128 nt
  buffer_load_dwordx4 v[104:107], v1, s[12:15], s24 offen offset:256 nt
  s_add_u32 s24, s24, 3072
  s_waitcnt vmcnt(12)
  v_lshlrev_b32 v123, 16, v108
  v_and_b32 v124, 0xffff0000, v108
  v_fmac_f32 v4, v40, v123
  v_fmac_f32 v5, v40, v124
  v_lshlrev_b32 v125, 16, v109
  v_and_b32 v126, 0xffff0000, v109
  v_fmac_f32 v6, v40, v125
  v_fmac_f32 v7, v40, v126
  v_lshlrev_b32 v123, 16, v110
  v_and_b32 v124, 0xffff0000, v110
  v_fmac_f32 v8, v40, v123
  v_fmac_f32 v9, v40, v124
  v_lshlrev_b32 v125, 16, v111
  v_and_b32 v126, 0xffff0000, v111
  v_fmac_f32 v10, v40, v125
  v_fmac_f32 v11, v40, v126
  v_lshlrev_b32 v123, 16, v112
  v_and_b32 v124, 0xffff0000, v112
  v_fmac_f32 v12, v40, v123
  v_fmac_f32 v13, v40, v124
  v_lshlrev_b32 v125, 16, v113
  v_and_b32 v126, 0xffff0000, v113
  v_fmac_f32 v14, v40, v125
  v_fmac_f32 v15, v40, v126
  v_lshlrev_b32 v123, 16, v114
  v_and_b32 v124, 0xffff0000, v114
  v_fmac_f32 v16, v40, v123
  v_fmac_f32 v17, v40, v124
  v_lshlrev_b32 v125, 16, v115
  v_and_b32 v126, 0xffff0000, v115
  v_fmac_f32 v18, v40, v125
  v_fmac_f32 v19, v40, v126
  v_lshlrev_b32 v123, 16, v116
  v_and_b32 v124, 0xffff0000, v116
  v_fmac_f32 v20, v40, v123
  v_fmac_f32 v21, v40, v124
  v_lshlrev_b32 v125, 16, v117
  v_and_b32 v126, 0xffff0000, v117
  v_fmac_f32 v22, v40, v125
  v_fmac_f32 v23, v40, v126
  v_lshlrev_b32 v123, 16, v118
  v_and_b32 v124, 0xffff0000, v118
  v_fmac_f32 v24, v40, v123
  v_fmac_f32 v25, v40, v124
  v_lshlrev_b32 v125, 16, v119
  v_and_b32 v126, 0xffff0000, v119
  v_fmac_f32 v26, v40, v125
  v_fmac_f32 v27, v40, v126
  buffer_load_dwordx4 v[108:111], v1, s[12:15], s24 offen offset:0 nt
  buffer_load_dwordx4 v[112:115], v1, s[12:15], s24 offen offset:128 nt
  buffer_load_dwordx4 v[116:119], v1, s[12:15], s24 offen offset:256 nt
  s_add_u32 s24, s24, 3072
  s_waitcnt vmcnt(12)
  v_lshlrev_b32 v123, 16, v60
  v_and_b32 v124, 0xffff0000, v60
  v_fmac_f32 v4, v41, v123
  v_fmac_f32 v5, v41, v124
  v_lshlrev_b32 v125, 16, v61
  v_and_b32 v126, 0xffff0000, v61
  v_fmac_f32 v6, v41, v125
  v_fmac_f32 v7, v41, v126
  v_lshlrev_b32 v123, 16, v62
  v_and_b32 v124, 0xffff0000, v62
  v_fmac_f32 v8, v41, v123
  v_fmac_f32 v9, v41, v124
  v_lshlrev_b32 v125, 16, v63
  v_and_b32 v126, 0xffff0000, v63
  v_fmac_f32 v10, v41, v125
  v_fmac_f32 v11, v41, v126
  v_lshlrev_b32 v123, 16, v64
  v_and_b32 v124, 0xffff0000, v64
  v_fmac_f32 v12, v41, v123
  v_fmac_f32 v13, v41, v124
  v_lshlrev_b32 v125, 16, v65
  v_and_b32 v126, 0xffff0000, v65
  v_fmac_f32 v14, v41, v125
  v_fmac_f32 v15, v41, v126
  v_lshlrev_b32 v123, 16, v66
  v_and_b32 v124, 0xffff0000, v66
  v_fmac_f32 v16, v41, v123
  v_fmac_f32 v17, v41, v124
  v_lshlrev_b32 v125, 16, v67
  v_and_b32 v126, 0xffff0000, v67
  v_fmac_f32 v18, v41, v125
  v_fmac_f32 v19, v41, v126
  v_lshlrev_b32 v123, 16, v68
  v_and_b32 v124, 0xffff0000, v68
  v_fmac_f32 v20, v41, v123
  v_fmac_f32 v21, v41, v124
  v_lshlrev_b32 v125, 16, v69
  v_and_b32 v126, 0xffff0000, v69
  v_fmac_f32 v22, v41, v125
  v_fmac_f32 v23, v41, v126
  v_lshlrev_b32 v123, 16, v70
  v_and_b32 v124, 0xffff0000, v70
  v_fmac_f32 v24, v41, v123
  v_fmac_f32 v25, v41, v124
  v_lshlrev_b32 v125, 16, v71
  v_and_b32 v126, 0xffff0000, v71
  v_fmac_f32 v26, v41, v125
  v_fmac_f32 v27, v41, v126
  buffer_load_dwordx4 v[60:63], v1, s[12:15], s24 offen offset:0 nt
  buffer_load_dwordx4 v[64:67], v1, s[12:15], s24 offen offset:128 nt
  buffer_load_dwordx4 v[68:71], v1, s[12:15], s24 offen offset:256 nt
  s_add_u32 s24, s24, 3072
  s_waitcnt vmcnt(12)
  v_lshlrev_b32 v123, 16, v72
  v_and_b32 v124, 0xffff0000, v72
  v_fmac_f32 v4, v42, v123
  v_fmac_f32 v5, v42, v124
  v_lshlrev_b32 v125, 16, v73
  v_and_b32 v126, 0xffff0000, v73
  v_fmac_f32 v6, v42, v125
  v_fmac_f32 v7, v42, v126
  v_lshlrev_b32 v123, 16, v74
  v_and_b32 v124, 0xffff0000, v74
  v_fmac_f32 v8, v42, v123
  v_fmac_f32 v9, v42, v124
  v_lshlrev_b32 v125, 16, v75
  v_and_b32 v126, 0xffff0000, v75
  v_fmac_f32 v10, v42, v125
  v_fmac_f32 v11, v42, v126
  v_lshlrev_b32 v123, 16, v76
  v_and_b32 v124, 0xffff0000, v76
  v_fmac_f32 v12, v42, v123
  v_fmac_f32 v13, v42, v124
  v_lshlrev_b32 v125, 16, v77
  v_and_b32 v126, 0xffff0000, v77
  v_fmac_f32 v14, v42, v125
  v_fmac_f32 v15, v42, v126
  v_lshlrev_b32 v123, 16, v78
  v_and_b32 v124, 0xffff0000, v78
  v_fmac_f32 v16, v42, v123
  v_fmac_f32 v17, v42, v124
  v_lshlrev_b32 v125, 16, v79
  v_and_b32 v126, 0xffff0000, v79
  v_fmac_f32 v18, v42, v125
  v_fmac_f32 v19, v42, v126
  v_lshlrev_b32 v123, 16, v80
  v_and_b32 v124, 0xffff0000, v80
  v_fmac_f32 v20, v42, v123
  v_fmac_f32 v21, v42, v124
  v_lshlrev_b32 v125, 16, v81
  v_and_b32 v126, 0xffff0000, v81
  v_fmac_f32 v22, v42, v125
  v_fmac_f32 v23, v42, v126
  v_lshlrev_b32 v123, 16, v82
  v_and_b32 v124, 0xffff0000, v82
  v_fmac_f32 v24, v42, v123
  v_fmac_f32 v25, v42, v124
  v_lshlrev_b32 v125, 16, v83
  v_and_b32 v126, 0xffff0000, v83
  v_fmac_f32 v26, v42, v125
  v_fmac_f32 v27, v42, v126
  buffer_load_dwordx4 v[72:75], v1, s[12:15], s24 offen offset:0 nt
  buffer_load_dwordx4 v[76:79], v1, s[12:15], s24 offen offset:128 nt
  buffer_load_dwordx4 v[80:83], v1, s[12:15], s24 offen offset:256 nt
  s_add_u32 s24, s24, 3072
  s_waitcnt vmcnt(12)
  v_lshlrev_b32 v123, 16, v84
  v_and_b32 v124, 0xffff0000, v84
  v_fmac_f32 v4, v43, v123
  v_fmac_f32 v5, v43, v124
  v_lshlrev_b32 v125, 16, v85
  v_and_b32 v126, 0xffff0000, v85
  v_fmac_f32 v6, v43, v125
  v_fmac_f32 v7, v43, v126
  v_lshlrev_b32 v123, 16, v86
  v_and_b32 v124, 0xffff0000, v86
  v_fmac_f32 v8, v43, v123
  v_fmac_f32 v9, v43, v124
  v_lshlrev_b32 v125, 16, v87
  v_and_b32 v126, 0xffff0000, v87
  v_fmac_f32 v10, v43, v125
  v_fmac_f32 v11, v43, v126
  v_lshlrev_b32 v123, 16, v88
  v_and_b32 v124, 0xffff0000, v88
  v_fmac_f32 v12, v43, v123
  v_fmac_f32 v13, v43, v124
  v_lshlrev_b32 v125, 16, v89
  v_and_b32 v126, 0xffff0000, v89
  v_fmac_f32 v14, v43, v125
  v_fmac_f32 v15, v43, v126
  v_lshlrev_b32 v123, 16, v90
  v_and_b32 v124, 0xffff0000, v90
  v_fmac_f32 v16, v43, v123
  v_fmac_f32 v17, v43, v124
  v_lshlrev_b32 v125, 16, v91
  v_and_b32 v126, 0xffff0000, v91
  v_fmac_f32 v18, v43, v125
  v_fmac_f32 v19, v43, v126
  v_lshlrev_b32 v123, 16, v92
  v_and_b32 v124, 0xffff0000, v92
  v_fmac_f32 v20, v43, v123
  v_fmac_f32 v21, v43, v124
  v_lshlrev_b32 v125, 16, v93
  v_and_b32 v126, 0xffff0000, v93
  v_fmac_f32 v22, v43, v125
  v_fmac_f32 v23, v43, v126
  v_lshlrev_b32 v123, 16, v94
  v_and_b32 v124, 0xffff0000, v94
  v_fmac_f32 v24, v43, v123
  v_fmac_f32 v25, v43, v124
  v_lshlrev_b32 v125, 16, v95
  v_and_b32 v126, 0xffff0000, v95
  v_fmac_f32 v26, v43, v125
  v_fmac_f32 v27, v43, v126
  buffer_load_dwordx4 v[84:87], v1, s[12:15], s24 offen offset:0 nt
  buffer_load_dwordx4 v[88:91], v1, s[12:15], s24 offen offset:128 nt
  buffer_load_dwordx4 v[92:95], v1, s[12:15], s24 offen offset:256 nt
  s_add_u32 s24, s24, 3072
  s_waitcnt vmcnt(12)
  v_lshlrev_b32 v123, 16, v96
  v_and_b32 v124, 0xffff0000, v96
  v_fmac_f32 v4, v44, v123
  v_fmac_f32 v5, v44, v124
  v_lshlrev_b32 v125, 16, v97
  v_and_b32 v126, 0xffff0000, v97
  v_fmac_f32 v6, v44, v125
  v_fmac_f32 v7, v44, v126
  v_lshlrev_b32 v123, 16, v98
  v_and_b32 v124, 0xffff0000, v98
  v_fmac_f32 v8, v44, v123
  v_fmac_f32 v9, v44, v124
  v_lshlrev_b32 v125, 16, v99
  v_and_b32 v126, 0xffff0000, v99
  v_fmac_f32 v10, v44, v125
  v_fmac_f32 v11, v44, v126
  v_lshlrev_b32 v123, 16, v100
  v_and_b32 v124, 0xffff0000, v100
  v_fmac_f32 v12, v44, v123
  v_fmac_f32 v13, v44, v124
  v_lshlrev_b32 v125, 16, v101
  v_and_b32 v126, 0xffff0000, v101
  v_fmac_f32 v14, v44, v125
  v_fmac_f32 v15, v44, v126
  v_lshlrev_b32 v123, 16, v102
  v_and_b32 v124, 0xffff0000, v102
  v_fmac_f32 v16, v44, v123
  v_fmac_f32 v17, v44, v124
  v_lshlrev_b32 v125, 16, v103
  v_and_b32 v126, 0xffff0000, v103
  v_fmac_f32 v18, v44, v125
  v_fmac_f32 v19, v44, v126
  v_lshlrev_b32 v123, 16, v104
  v_and_b32 v124, 0xffff0000, v104
  v_fmac_f32 v20, v44, v123
  v_fmac_f32 v21, v44, v124
  v_lshlrev_b32 v125, 16, v105
  v_and_b32 v126, 0xffff0000, v105
  v_fmac_f32 v22, v44, v125
  v_fmac_f32 v23, v44, v126
  v_lshlrev_b32 v123, 16, v106
  v_and_b32 v124, 0xffff0000, v106
  v_fmac_f32 v24, v44, v123
  v_fmac_f32 v25, v44, v124
  v_lshlrev_b32 v125, 16, v107
  v_and_b32 v126, 0xffff0000, v107
  v_fmac_f32 v26, v44, v125
  v_fmac_f32 v27, v44, v126
  buffer_load_dwordx4 v[96:99], v1, s[12:15], s24 offen offset:0 nt
  buffer_load_dwordx4 v[100:103], v1, s[12:15], s24 offen offset:128 nt
  buffer_load_dwordx4 v[104:107], v1, s[12:15], s24 offen offset:256 nt
  s_add_u32 s24, s24, 3072
  s_waitcnt vmcnt(12)
  v_lshlrev_b32 v123, 16, v108
  v_and_b32 v124, 0xffff0000, v108
  v_fmac_f32 v4, v45, v123
  v_fmac_f32 v5, v45, v124
  v_lshlrev_b32 v125, 16, v109
  v_and_b32 v126, 0xffff0000, v109
  v_fmac_f32 v6, v45, v125
  v_fmac_f32 v7, v45, v126
  v_lshlrev_b32 v123, 16, v110
  v_and_b32 v124, 0xffff0000, v110
  v_fmac_f32 v8, v45, v123
  v_fmac_f32 v9, v45, v124
  v_lshlrev_b32 v125, 16, v111
  v_and_b32 v126, 0xffff0000, v111
  v_fmac_f32 v10, v45, v125
  v_fmac_f32 v11, v45, v126
  v_lshlrev_b32 v123, 16, v112
  v_and_b32 v124, 0xffff0000, v112
  v_fmac_f32 v12, v45, v123
  v_fmac_f32 v13, v45, v124
  v_lshlrev_b32 v125, 16, v113
  v_and_b32 v126, 0xffff0000, v113
  v_fmac_f32 v14, v45, v125
  v_fmac_f32 v15, v45, v126
  v_lshlrev_b32 v123, 16, v114
  v_and_b32 v124, 0xffff0000, v114
  v_fmac_f32 v16, v45, v123
  v_fmac_f32 v17, v45, v124
  v_lshlrev_b32 v125, 16, v115
  v_and_b32 v126, 0xffff0000, v115
  v_fmac_f32 v18, v45, v125
  v_fmac_f32 v19, v45, v126
  v_lshlrev_b32 v123, 16, v116
  v_and_b32 v124, 0xffff0000, v116
  v_fmac_f32 v20, v45, v123
  v_fmac_f32 v21, v45, v124
  v_lshlrev_b32 v125, 16, v117
  v_and_b32 v126, 0xffff0000, v117
  v_fmac_f32 v22, v45, v125
  v_fmac_f32 v23, v45, v126
  v_lshlrev_b32 v123, 16, v118
  v_and_b32 v124, 0xffff0000, v118
  v_fmac_f32 v24, v45, v123
  v_fmac_f32 v25, v45, v124
  v_lshlrev_b32 v125, 16, v119
  v_and_b32 v126, 0xffff0000, v119
  v_fmac_f32 v26, v45, v125
  v_fmac_f32 v27, v45, v126
  buffer_load_dwordx4 v[108:111], v1, s[12:15], s24 offen offset:0 nt
  buffer_load_dwordx4 v[112:115], v1, s[12:15], s24 offen offset:128 nt
  buffer_load_dwordx4 v[116:119], v1, s[12:15], s24 offen offset:256 nt
  s_add_u32 s24, s24, 3072
  s_waitcnt vmcnt(12)
  v_lshlrev_b32 v123, 16, v60
  v_and_b32 v124, 0xffff0000, v60
  v_fmac_f32 v4, v46, v123
  v_fmac_f32 v5, v46, v124
  v_lshlrev_b32 v125, 16, v61
  v_and_b32 v126, 0xffff0000, v61
  v_fmac_f32 v6, v46, v125
  v_fmac_f32 v7, v46, v126
  v_lshlrev_b32 v123, 16, v62
  v_and_b32 v124, 0xffff0000, v62
  v_fmac_f32 v8, v46, v123
  v_fmac_f32 v9, v46, v124
  v_lshlrev_b32 v125, 16, v63
  v_and_b32 v126, 0xffff0000, v63
  v_fmac_f32 v10, v46, v125
  v_fmac_f32 v11, v46, v126
  v_lshlrev_b32 v123, 16, v64
  v_and_b32 v124, 0xffff0000, v64
  v_fmac_f32 v12, v46, v123
  v_fmac_f32 v13, v46, v124
  v_lshlrev_b32 v125, 16, v65
  v_and_b32 v126, 0xffff0000, v65
  v_fmac_f32 v14, v46, v125
  v_fmac_f32 v15, v46, v126
  v_lshlrev_b32 v123, 16, v66
  v_and_b32 v124, 0xffff0000, v66
  v_fmac_f32 v16, v46, v123
  v_fmac_f32 v17, v46, v124
  v_lshlrev_b32 v125, 16, v67
  v_and_b32 v126, 0xffff0000, v67
  v_fmac_f32 v18, v46, v125
  v_fmac_f32 v19, v46, v126
  v_lshlrev_b32 v123, 16, v68
  v_and_b32 v124, 0xffff0000, v68
  v_fmac_f32 v20, v46, v123
  v_fmac_f32 v21, v46, v124
  v_lshlrev_b32 v125, 16, v69
  v_and_b32 v126, 0xffff0000, v69
  v_fmac_f32 v22, v46, v125
  v_fmac_f32 v23, v46, v126
  v_lshlrev_b32 v123, 16, v70
  v_and_b32 v124, 0xffff0000, v70
  v_fmac_f32 v24, v46, v123
  v_fmac_f32 v25, v46, v124
  v_lshlrev_b32 v125, 16, v71
  v_and_b32 v126, 0xffff0000, v71
  v_fmac_f32 v26, v46, v125
  v_fmac_f32 v27, v46, v126
  buffer_load_dwordx4 v[60:63], v1, s[12:15], s24 offen offset:0 nt
  buffer_load_dwordx4 v[64:67], v1, s[12:15], s24 offen offset:128 nt
  buffer_load_dwordx4 v[68:71], v1, s[12:15], s24 offen offset:256 nt
  s_add_u32 s24, s24, 3072
  s_waitcnt vmcnt(12)
  v_lshlrev_b32 v123, 16, v72
  v_and_b32 v124, 0xffff0000, v72
  v_fmac_f32 v4, v47, v123
  v_fmac_f32 v5, v47, v124
  v_lshlrev_b32 v125, 16, v73
  v_and_b32 v126, 0xffff0000, v73
  v_fmac_f32 v6, v47, v125
  v_fmac_f32 v7, v47, v126
  v_lshlrev_b32 v123, 16, v74
  v_and_b32 v124, 0xffff0000, v74
  v_fmac_f32 v8, v47, v123
  v_fmac_f32 v9, v47, v124
  v_lshlrev_b32 v125, 16, v75
  v_and_b32 v126, 0xffff0000, v75
  v_fmac_f32 v10, v47, v125
  v_fmac_f32 v11, v47, v126
  v_lshlrev_b32 v123, 16, v76
  v_and_b32 v124, 0xffff0000, v76
  v_fmac_f32 v12, v47, v123
  v_fmac_f32 v13, v47, v124
  v_lshlrev_b32 v125, 16, v77
  v_and_b32 v126, 0xffff0000, v77
  v_fmac_f32 v14, v47, v125
  v_fmac_f32 v15, v47, v126
  v_lshlrev_b32 v123, 16, v78
  v_and_b32 v124, 0xffff0000, v78
  v_fmac_f32 v16, v47, v123
  v_fmac_f32 v17, v47, v124
  v_lshlrev_b32 v125, 16, v79
  v_and_b32 v126, 0xffff0000, v79
  v_fmac_f32 v18, v47, v125
  v_fmac_f32 v19, v47, v126
  v_lshlrev_b32 v123, 16, v80
  v_and_b32 v124, 0xffff0000, v80
  v_fmac_f32 v20, v47, v123
  v_fmac_f32 v21, v47, v124
  v_lshlrev_b32 v125, 16, v81
  v_and_b32 v126, 0xffff0000, v81
  v_fmac_f32 v22, v47, v125
  v_fmac_f32 v23, v47, v126
  v_lshlrev_b32 v123, 16, v82
  v_and_b32 v124, 0xffff0000, v82
  v_fmac_f32 v24, v47, v123
  v_fmac_f32 v25, v47, v124
  v_lshlrev_b32 v125, 16, v83
  v_and_b32 v126, 0xffff0000, v83
  v_fmac_f32 v26, v47, v125
  v_fmac_f32 v27, v47, v126
  buffer_load_dwordx4 v[72:75], v1, s[12:15], s24 offen offset:0 nt
  buffer_load_dwordx4 v[76:79], v1, s[12:15], s24 offen offset:128 nt
  buffer_load_dwordx4 v[80:83], v1, s[12:15], s24 offen offset:256 nt
  s_add_u32 s24, s24, 3072
  s_waitcnt vmcnt(12)
  v_lshlrev_b32 v123, 16, v84
  v_and_b32 v124, 0xffff0000, v84
  v_fmac_f32 v4, v48, v123
  v_fmac_f32 v5, v48, v124
  v_lshlrev_b32 v125, 16, v85
  v_and_b32 v126, 0xffff0000, v85
  v_fmac_f32 v6, v48, v125
  v_fmac_f32 v7, v48, v126
  v_lshlrev_b32 v123, 16, v86
  v_and_b32 v124, 0xffff0000, v86
  v_fmac_f32 v8, v48, v123
  v_fmac_f32 v9, v48, v124
  v_lshlrev_b32 v125, 16, v87
  v_and_b32 v126, 0xffff0000, v87
  v_fmac_f32 v10, v48, v125
  v_fmac_f32 v11, v48, v126
  v_lshlrev_b32 v123, 16, v88
  v_and_b32 v124, 0xffff0000, v88
  v_fmac_f32 v12, v48, v123
  v_fmac_f32 v13, v48, v124
  v_lshlrev_b32 v125, 16, v89
  v_and_b32 v126, 0xffff0000, v89
  v_fmac_f32 v14, v48, v125
  v_fmac_f32 v15, v48, v126
  v_lshlrev_b32 v123, 16, v90
  v_and_b32 v124, 0xffff0000, v90
  v_fmac_f32 v16, v48, v123
  v_fmac_f32 v17, v48, v124
  v_lshlrev_b32 v125, 16, v91
  v_and_b32 v126, 0xffff0000, v91
  v_fmac_f32 v18, v48, v125
  v_fmac_f32 v19, v48, v126
  v_lshlrev_b32 v123, 16, v92
  v_and_b32 v124, 0xffff0000, v92
  v_fmac_f32 v20, v48, v123
  v_fmac_f32 v21, v48, v124
  v_lshlrev_b32 v125, 16, v93
  v_and_b32 v126, 0xffff0000, v93
  v_fmac_f32 v22, v48, v125
  v_fmac_f32 v23, v48, v126
  v_lshlrev_b32 v123, 16, v94
  v_and_b32 v124, 0xffff0000, v94
  v_fmac_f32 v24, v48, v123
  v_fmac_f32 v25, v48, v124
  v_lshlrev_b32 v125, 16, v95
  v_and_b32 v126, 0xffff0000, v95
  v_fmac_f32 v26, v48, v125
  v_fmac_f32 v27, v48, v126
  buffer_load_dwordx4 v[84:87], v1, s[12:15], s24 offen offset:0 nt
  buffer_load_dwordx4 v[88:91], v1, s[12:15], s24 offen offset:128 nt
  buffer_load_dwordx4 v[92:95], v1, s[12:15], s24 offen offset:256 nt
  s_add_u32 s24, s24, 3072
  s_waitcnt vmcnt(12)
  v_lshlrev_b32 v123, 16, v96
  v_and_b32 v124, 0xffff0000, v96
  v_fmac_f32 v4, v49, v123
  v_fmac_f32 v5, v49, v124
  v_lshlrev_b32 v125, 16, v97
  v_and_b32 v126, 0xffff0000, v97
  v_fmac_f32 v6, v49, v125
  v_fmac_f32 v7, v49, v126
  v_lshlrev_b32 v123, 16, v98
  v_and_b32 v124, 0xffff0000, v98
  v_fmac_f32 v8, v49, v123
  v_fmac_f32 v9, v49, v124
  v_lshlrev_b32 v125, 16, v99
  v_and_b32 v126, 0xffff0000, v99
  v_fmac_f32 v10, v49, v125
  v_fmac_f32 v11, v49, v126
  v_lshlrev_b32 v123, 16, v100
  v_and_b32 v124, 0xffff0000, v100
  v_fmac_f32 v12, v49, v123
  v_fmac_f32 v13, v49, v124
  v_lshlrev_b32 v125, 16, v101
  v_and_b32 v126, 0xffff0000, v101
  v_fmac_f32 v14, v49, v125
  v_fmac_f32 v15, v49, v126
  v_lshlrev_b32 v123, 16, v102
  v_and_b32 v124, 0xffff0000, v102
  v_fmac_f32 v16, v49, v123
  v_fmac_f32 v17, v49, v124
  v_lshlrev_b32 v125, 16, v103
  v_and_b32 v126, 0xffff0000, v103
  v_fmac_f32 v18, v49, v125
  v_fmac_f32 v19, v49, v126
  v_lshlrev_b32 v123, 16, v104
  v_and_b32 v124, 0xffff0000, v104
  v_fmac_f32 v20, v49, v123
  v_fmac_f32 v21, v49, v124
  v_lshlrev_b32 v125, 16, v105
  v_and_b32 v126, 0xffff0000, v105
  v_fmac_f32 v22, v49, v125
  v_fmac_f32 v23, v49, v126
  v_lshlrev_b32 v123, 16, v106
  v_and_b32 v124, 0xffff0000, v106
  v_fmac_f32 v24, v49, v123
  v_fmac_f32 v25, v49, v124
  v_lshlrev_b32 v125, 16, v107
  v_and_b32 v126, 0xffff0000, v107
  v_fmac_f32 v26, v49, v125
  v_fmac_f32 v27, v49, v126
  buffer_load_dwordx4 v[96:99], v1, s[12:15], s24 offen offset:0 nt
  buffer_load_dwordx4 v[100:103], v1, s[12:15], s24 offen offset:128 nt
  buffer_load_dwordx4 v[104:107], v1, s[12:15], s24 offen offset:256 nt
  s_add_u32 s24, s24, 3072
  s_waitcnt vmcnt(12)
  v_lshlrev_b32 v123, 16, v108
  v_and_b32 v124, 0xffff0000, v108
  v_fmac_f32 v4, v50, v123
  v_fmac_f32 v5, v50, v124
  v_lshlrev_b32 v125, 16, v109
  v_and_b32 v126, 0xffff0000, v109
  v_fmac_f32 v6, v50, v125
  v_fmac_f32 v7, v50, v126
  v_lshlrev_b32 v123, 16, v110
  v_and_b32 v124, 0xffff0000, v110
  v_fmac_f32 v8, v50, v123
  v_fmac_f32 v9, v50, v124
  v_lshlrev_b32 v125, 16, v111
  v_and_b32 v126, 0xffff0000, v111
  v_fmac_f32 v10, v50, v125
  v_fmac_f32 v11, v50, v126
  v_lshlrev_b32 v123, 16, v112
  v_and_b32 v124, 0xffff0000, v112
  v_fmac_f32 v12, v50, v123
  v_fmac_f32 v13, v50, v124
  v_lshlrev_b32 v125, 16, v113
  v_and_b32 v126, 0xffff0000, v113
  v_fmac_f32 v14, v50, v125
  v_fmac_f32 v15, v50, v126
  v_lshlrev_b32 v123, 16, v114
  v_and_b32 v124, 0xffff0000, v114
  v_fmac_f32 v16, v50, v123
  v_fmac_f32 v17, v50, v124
  v_lshlrev_b32 v125, 16, v115
  v_and_b32 v126, 0xffff0000, v115
  v_fmac_f32 v18, v50, v125
  v_fmac_f32 v19, v50, v126
  v_lshlrev_b32 v123, 16, v116
  v_and_b32 v124, 0xffff0000, v116
  v_fmac_f32 v20, v50, v123
  v_fmac_f32 v21, v50, v124
  v_lshlrev_b32 v125, 16, v117
  v_and_b32 v126, 0xffff0000, v117
  v_fmac_f32 v22, v50, v125
  v_fmac_f32 v23, v50, v126
  v_lshlrev_b32 v123, 16, v118
  v_and_b32 v124, 0xffff0000, v118
  v_fmac_f32 v24, v50, v123
  v_fmac_f32 v25, v50, v124
  v_lshlrev_b32 v125, 16, v119
  v_and_b32 v126, 0xffff0000, v119
  v_fmac_f32 v26, v50, v125
  v_fmac_f32 v27, v50, v126
  buffer_load_dwordx4 v[108:111], v1, s[12:15], s24 offen offset:0 nt
  buffer_load_dwordx4 v[112:115], v1, s[12:15], s24 offen offset:128 nt
  buffer_load_dwordx4 v[116:119], v1, s[12:15], s24 offen offset:256 nt
  s_add_u32 s24, s24, 3072
  s_waitcnt vmcnt(12)
  v_lshlrev_b32 v123, 16, v60
  v_and_b32 v124, 0xffff0000, v60
  v_fmac_f32 v4, v51, v123
  v_fmac_f32 v5, v51, v124
  v_lshlrev_b32 v125, 16, v61
  v_and_b32 v126, 0xffff0000, v61
  v_fmac_f32 v6, v51, v125
  v_fmac_f32 v7, v51, v126
  v_lshlrev_b32 v123, 16, v62
  v_and_b32 v124, 0xffff0000, v62
  v_fmac_f32 v8, v51, v123
  v_fmac_f32 v9, v51, v124
  v_lshlrev_b32 v125, 16, v63
  v_and_b32 v126, 0xffff0000, v63
  v_fmac_f32 v10, v51, v125
  v_fmac_f32 v11, v51, v126
  v_lshlrev_b32 v123, 16, v64
  v_and_b32 v124, 0xffff0000, v64
  v_fmac_f32 v12, v51, v123
  v_fmac_f32 v13, v51, v124
  v_lshlrev_b32 v125, 16, v65
  v_and_b32 v126, 0xffff0000, v65
  v_fmac_f32 v14, v51, v125
  v_fmac_f32 v15, v51, v126
  v_lshlrev_b32 v123, 16, v66
  v_and_b32 v124, 0xffff0000, v66
  v_fmac_f32 v16, v51, v123
  v_fmac_f32 v17, v51, v124
  v_lshlrev_b32 v125, 16, v67
  v_and_b32 v126, 0xffff0000, v67
  v_fmac_f32 v18, v51, v125
  v_fmac_f32 v19, v51, v126
  v_lshlrev_b32 v123, 16, v68
  v_and_b32 v124, 0xffff0000, v68
  v_fmac_f32 v20, v51, v123
  v_fmac_f32 v21, v51, v124
  v_lshlrev_b32 v125, 16, v69
  v_and_b32 v126, 0xffff0000, v69
  v_fmac_f32 v22, v51, v125
  v_fmac_f32 v23, v51, v126
  v_lshlrev_b32 v123, 16, v70
  v_and_b32 v124, 0xffff0000, v70
  v_fmac_f32 v24, v51, v123
  v_fmac_f32 v25, v51, v124
  v_lshlrev_b32 v125, 16, v71
  v_and_b32 v126, 0xffff0000, v71
  v_fmac_f32 v26, v51, v125
  v_fmac_f32 v27, v51, v126
  buffer_load_dwordx4 v[60:63], v1, s[12:15], s24 offen offset:0 nt
  buffer_load_dwordx4 v[64:67], v1, s[12:15], s24 offen offset:128 nt
  buffer_load_dwordx4 v[68:71], v1, s[12:15], s24 offen offset:256 nt
  s_add_u32 s24, s24, 3072
  s_waitcnt vmcnt(12)
  v_lshlrev_b32 v123, 16, v72
  v_and_b32 v124, 0xffff0000, v72
  v_fmac_f32 v4, v52, v123
  v_fmac_f32 v5, v52, v124
  v_lshlrev_b32 v125, 16, v73
  v_and_b32 v126, 0xffff0000, v73
  v_fmac_f32 v6, v52, v125
  v_fmac_f32 v7, v52, v126
  v_lshlrev_b32 v123, 16, v74
  v_and_b32 v124, 0xffff0000, v74
  v_fmac_f32 v8, v52, v123
  v_fmac_f32 v9, v52, v124
  v_lshlrev_b32 v125, 16, v75
  v_and_b32 v126, 0xffff0000, v75
  v_fmac_f32 v10, v52, v125
  v_fmac_f32 v11, v52, v126
  v_lshlrev_b32 v123, 16, v76
  v_and_b32 v124, 0xffff0000, v76
  v_fmac_f32 v12, v52, v123
  v_fmac_f32 v13, v52, v124
  v_lshlrev_b32 v125, 16, v77
  v_and_b32 v126, 0xffff0000, v77
  v_fmac_f32 v14, v52, v125
  v_fmac_f32 v15, v52, v126
  v_lshlrev_b32 v123, 16, v78
  v_and_b32 v124, 0xffff0000, v78
  v_fmac_f32 v16, v52, v123
  v_fmac_f32 v17, v52, v124
  v_lshlrev_b32 v125, 16, v79
  v_and_b32 v126, 0xffff0000, v79
  v_fmac_f32 v18, v52, v125
  v_fmac_f32 v19, v52, v126
  v_lshlrev_b32 v123, 16, v80
  v_and_b32 v124, 0xffff0000, v80
  v_fmac_f32 v20, v52, v123
  v_fmac_f32 v21, v52, v124
  v_lshlrev_b32 v125, 16, v81
  v_and_b32 v126, 0xffff0000, v81
  v_fmac_f32 v22, v52, v125
  v_fmac_f32 v23, v52, v126
  v_lshlrev_b32 v123, 16, v82
  v_and_b32 v124, 0xffff0000, v82
  v_fmac_f32 v24, v52, v123
  v_fmac_f32 v25, v52, v124
  v_lshlrev_b32 v125, 16, v83
  v_and_b32 v126, 0xffff0000, v83
  v_fmac_f32 v26, v52, v125
  v_fmac_f32 v27, v52, v126
  buffer_load_dwordx4 v[72:75], v1, s[12:15], s24 offen offset:0 nt
  buffer_load_dwordx4 v[76:79], v1, s[12:15], s24 offen offset:128 nt
  buffer_load_dwordx4 v[80:83], v1, s[12:15], s24 offen offset:256 nt
  s_add_u32 s24, s24, 3072
  s_waitcnt vmcnt(12)
  v_lshlrev_b32 v123, 16, v84
  v_and_b32 v124, 0xffff0000, v84
  v_fmac_f32 v4, v53, v123
  v_fmac_f32 v5, v53, v124
  v_lshlrev_b32 v125, 16, v85
  v_and_b32 v126, 0xffff0000, v85
  v_fmac_f32 v6, v53, v125
  v_fmac_f32 v7, v53, v126
  v_lshlrev_b32 v123, 16, v86
  v_and_b32 v124, 0xffff0000, v86
  v_fmac_f32 v8, v53, v123
  v_fmac_f32 v9, v53, v124
  v_lshlrev_b32 v125, 16, v87
  v_and_b32 v126, 0xffff0000, v87
  v_fmac_f32 v10, v53, v125
  v_fmac_f32 v11, v53, v126
  v_lshlrev_b32 v123, 16, v88
  v_and_b32 v124, 0xffff0000, v88
  v_fmac_f32 v12, v53, v123
  v_fmac_f32 v13, v53, v124
  v_lshlrev_b32 v125, 16, v89
  v_and_b32 v126, 0xffff0000, v89
  v_fmac_f32 v14, v53, v125
  v_fmac_f32 v15, v53, v126
  v_lshlrev_b32 v123, 16, v90
  v_and_b32 v124, 0xffff0000, v90
  v_fmac_f32 v16, v53, v123
  v_fmac_f32 v17, v53, v124
  v_lshlrev_b32 v125, 16, v91
  v_and_b32 v126, 0xffff0000, v91
  v_fmac_f32 v18, v53, v125
  v_fmac_f32 v19, v53, v126
  v_lshlrev_b32 v123, 16, v92
  v_and_b32 v124, 0xffff0000, v92
  v_fmac_f32 v20, v53, v123
  v_fmac_f32 v21, v53, v124
  v_lshlrev_b32 v125, 16, v93
  v_and_b32 v126, 0xffff0000, v93
  v_fmac_f32 v22, v53, v125
  v_fmac_f32 v23, v53, v126
  v_lshlrev_b32 v123, 16, v94
  v_and_b32 v124, 0xffff0000, v94
  v_fmac_f32 v24, v53, v123
  v_fmac_f32 v25, v53, v124
  v_lshlrev_b32 v125, 16, v95
  v_and_b32 v126, 0xffff0000, v95
  v_fmac_f32 v26, v53, v125
  v_fmac_f32 v27, v53, v126
  buffer_load_dwordx4 v[84:87], v1, s[12:15], s24 offen offset:0 nt
  buffer_load_dwordx4 v[88:91], v1, s[12:15], s24 offen offset:128 nt
  buffer_load_dwordx4 v[92:95], v1, s[12:15], s24 offen offset:256 nt
  s_add_u32 s24, s24, 3072
  s_waitcnt vmcnt(12)
  v_lshlrev_b32 v123, 16, v96
  v_and_b32 v124, 0xffff0000, v96
  v_fmac_f32 v4, v54, v123
  v_fmac_f32 v5, v54, v124
  v_lshlrev_b32 v125, 16, v97
  v_and_b32 v126, 0xffff0000, v97
  v_fmac_f32 v6, v54, v125
  v_fmac_f32 v7, v54, v126
  v_lshlrev_b32 v123, 16, v98
  v_and_b32 v124, 0xffff0000, v98
  v_fmac_f32 v8, v54, v123
  v_fmac_f32 v9, v54, v124
  v_lshlrev_b32 v125, 16, v99
  v_and_b32 v126, 0xffff0000, v99
  v_fmac_f32 v10, v54, v125
  v_fmac_f32 v11, v54, v126
  v_lshlrev_b32 v123, 16, v100
  v_and_b32 v124, 0xffff0000, v100
  v_fmac_f32 v12, v54, v123
  v_fmac_f32 v13, v54, v124
  v_lshlrev_b32 v125, 16, v101
  v_and_b32 v126, 0xffff0000, v101
  v_fmac_f32 v14, v54, v125
  v_fmac_f32 v15, v54, v126
  v_lshlrev_b32 v123, 16, v102
  v_and_b32 v124, 0xffff0000, v102
  v_fmac_f32 v16, v54, v123
  v_fmac_f32 v17, v54, v124
  v_lshlrev_b32 v125, 16, v103
  v_and_b32 v126, 0xffff0000, v103
  v_fmac_f32 v18, v54, v125
  v_fmac_f32 v19, v54, v126
  v_lshlrev_b32 v123, 16, v104
  v_and_b32 v124, 0xffff0000, v104
  v_fmac_f32 v20, v54, v123
  v_fmac_f32 v21, v54, v124
  v_lshlrev_b32 v125, 16, v105
  v_and_b32 v126, 0xffff0000, v105
  v_fmac_f32 v22, v54, v125
  v_fmac_f32 v23, v54, v126
  v_lshlrev_b32 v123, 16, v106
  v_and_b32 v124, 0xffff0000, v106
  v_fmac_f32 v24, v54, v123
  v_fmac_f32 v25, v54, v124
  v_lshlrev_b32 v125, 16, v107
  v_and_b32 v126, 0xffff0000, v107
  v_fmac_f32 v26, v54, v125
  v_fmac_f32 v27, v54, v126
  buffer_load_dwordx4 v[96:99], v1, s[12:15], s24 offen offset:0 nt
  buffer_load_dwordx4 v[100:103], v1, s[12:15], s24 offen offset:128 nt
  buffer_load_dwordx4 v[104:107], v1, s[12:15], s24 offen offset:256 nt
  s_add_u32 s24, s24, 3072
  s_waitcnt vmcnt(12)
  v_lshlrev_b32 v123, 16, v108
  v_and_b32 v124, 0xffff0000, v108
  v_fmac_f32 v4, v55, v123
  v_fmac_f32 v5, v55, v124
  v_lshlrev_b32 v125, 16, v109
  v_and_b32 v126, 0xffff0000, v109
  v_fmac_f32 v6, v55, v125
  v_fmac_f32 v7, v55, v126
  v_lshlrev_b32 v123, 16, v110
  v_and_b32 v124, 0xffff0000, v110
  v_fmac_f32 v8, v55, v123
  v_fmac_f32 v9, v55, v124
  v_lshlrev_b32 v125, 16, v111
  v_and_b32 v126, 0xffff0000, v111
  v_fmac_f32 v10, v55, v125
  v_fmac_f32 v11, v55, v126
  v_lshlrev_b32 v123, 16, v112
  v_and_b32 v124, 0xffff0000, v112
  v_fmac_f32 v12, v55, v123
  v_fmac_f32 v13, v55, v124
  v_lshlrev_b32 v125, 16, v113
  v_and_b32 v126, 0xffff0000, v113
  v_fmac_f32 v14, v55, v125
  v_fmac_f32 v15, v55, v126
  v_lshlrev_b32 v123, 16, v114
  v_and_b32 v124, 0xffff0000, v114
  v_fmac_f32 v16, v55, v123
  v_fmac_f32 v17, v55, v124
  v_lshlrev_b32 v125, 16, v115
  v_and_b32 v126, 0xffff0000, v115
  v_fmac_f32 v18, v55, v125
  v_fmac_f32 v19, v55, v126
  v_lshlrev_b32 v123, 16, v116
  v_and_b32 v124, 0xffff0000, v116
  v_fmac_f32 v20, v55, v123
  v_fmac_f32 v21, v55, v124
  v_lshlrev_b32 v125, 16, v117
  v_and_b32 v126, 0xffff0000, v117
  v_fmac_f32 v22, v55, v125
  v_fmac_f32 v23, v55, v126
  v_lshlrev_b32 v123, 16, v118
  v_and_b32 v124, 0xffff0000, v118
  v_fmac_f32 v24, v55, v123
  v_fmac_f32 v25, v55, v124
  v_lshlrev_b32 v125, 16, v119
  v_and_b32 v126, 0xffff0000, v119
  v_fmac_f32 v26, v55, v125
  v_fmac_f32 v27, v55, v126
  s_waitcnt vmcnt(9)
  v_lshlrev_b32 v123, 16, v60
  v_and_b32 v124, 0xffff0000, v60
  v_fmac_f32 v4, v56, v123
  v_fmac_f32 v5, v56, v124
  v_lshlrev_b32 v125, 16, v61
  v_and_b32 v126, 0xffff0000, v61
  v_fmac_f32 v6, v56, v125
  v_fmac_f32 v7, v56, v126
  v_lshlrev_b32 v123, 16, v62
  v_and_b32 v124, 0xffff0000, v62
  v_fmac_f32 v8, v56, v123
  v_fmac_f32 v9, v56, v124
  v_lshlrev_b32 v125, 16, v63
  v_and_b32 v126, 0xffff0000, v63
  v_fmac_f32 v10, v56, v125
  v_fmac_f32 v11, v56, v126
  v_lshlrev_b32 v123, 16, v64
  v_and_b32 v124, 0xffff0000, v64
  v_fmac_f32 v12, v56, v123
  v_fmac_f32 v13, v56, v124
  v_lshlrev_b32 v125, 16, v65
  v_and_b32 v126, 0xffff0000, v65
  v_fmac_f32 v14, v56, v125
  v_fmac_f32 v15, v56, v126
  v_lshlrev_b32 v123, 16, v66
  v_and_b32 v124, 0xffff0000, v66
  v_fmac_f32 v16, v56, v123
  v_fmac_f32 v17, v56, v124
  v_lshlrev_b32 v125, 16, v67
  v_and_b32 v126, 0xffff0000, v67
  v_fmac_f32 v18, v56, v125
  v_fmac_f32 v19, v56, v126
  v_lshlrev_b32 v123, 16, v68
  v_and_b32 v124, 0xffff0000, v68
  v_fmac_f32 v20, v56, v123
  v_fmac_f32 v21, v56, v124
  v_lshlrev_b32 v125, 16, v69
  v_and_b32 v126, 0xffff0000, v69
  v_fmac_f32 v22, v56, v125
  v_fmac_f32 v23, v56, v126
  v_lshlrev_b32 v123, 16, v70
  v_and_b32 v124, 0xffff0000, v70
  v_fmac_f32 v24, v56, v123
  v_fmac_f32 v25, v56, v124
  v_lshlrev_b32 v125, 16, v71
  v_and_b32 v126, 0xffff0000, v71
  v_fmac_f32 v26, v56, v125
  v_fmac_f32 v27, v56, v126
  s_waitcnt vmcnt(6)
  v_lshlrev_b32 v123, 16, v72
  v_and_b32 v124, 0xffff0000, v72
  v_fmac_f32 v4, v57, v123
  v_fmac_f32 v5, v57, v124
  v_lshlrev_b32 v125, 16, v73
  v_and_b32 v126, 0xffff0000, v73
  v_fmac_f32 v6, v57, v125
  v_fmac_f32 v7, v57, v126
  v_lshlrev_b32 v123, 16, v74
  v_and_b32 v124, 0xffff0000, v74
  v_fmac_f32 v8, v57, v123
  v_fmac_f32 v9, v57, v124
  v_lshlrev_b32 v125, 16, v75
  v_and_b32 v126, 0xffff0000, v75
  v_fmac_f32 v10, v57, v125
  v_fmac_f32 v11, v57, v126
  v_lshlrev_b32 v123, 16, v76
  v_and_b32 v124, 0xffff0000, v76
  v_fmac_f32 v12, v57, v123
  v_fmac_f32 v13, v57, v124
  v_lshlrev_b32 v125, 16, v77
  v_and_b32 v126, 0xffff0000, v77
  v_fmac_f32 v14, v57, v125
  v_fmac_f32 v15, v57, v126
  v_lshlrev_b32 v123, 16, v78
  v_and_b32 v124, 0xffff0000, v78
  v_fmac_f32 v16, v57, v123
  v_fmac_f32 v17, v57, v124
  v_lshlrev_b32 v125, 16, v79
  v_and_b32 v126, 0xffff0000, v79
  v_fmac_f32 v18, v57, v125
  v_fmac_f32 v19, v57, v126
  v_lshlrev_b32 v123, 16, v80
  v_and_b32 v124, 0xffff0000, v80
  v_fmac_f32 v20, v57, v123
  v_fmac_f32 v21, v57, v124
  v_lshlrev_b32 v125, 16, v81
  v_and_b32 v126, 0xffff0000, v81
  v_fmac_f32 v22, v57, v125
  v_fmac_f32 v23, v57, v126
  v_lshlrev_b32 v123, 16, v82
  v_and_b32 v124, 0xffff0000, v82
  v_fmac_f32 v24, v57, v123
  v_fmac_f32 v25, v57, v124
  v_lshlrev_b32 v125, 16, v83
  v_and_b32 v126, 0xffff0000, v83
  v_fmac_f32 v26, v57, v125
  v_fmac_f32 v27, v57, v126
  s_waitcnt vmcnt(3)
  v_lshlrev_b32 v123, 16, v84
  v_and_b32 v124, 0xffff0000, v84
  v_fmac_f32 v4, v58, v123
  v_fmac_f32 v5, v58, v124
  v_lshlrev_b32 v125, 16, v85
  v_and_b32 v126, 0xffff0000, v85
  v_fmac_f32 v6, v58, v125
  v_fmac_f32 v7, v58, v126
  v_lshlrev_b32 v123, 16, v86
  v_and_b32 v124, 0xffff0000, v86
  v_fmac_f32 v8, v58, v123
  v_fmac_f32 v9, v58, v124
  v_lshlrev_b32 v125, 16, v87
  v_and_b32 v126, 0xffff0000, v87
  v_fmac_f32 v10, v58, v125
  v_fmac_f32 v11, v58, v126
  v_lshlrev_b32 v123, 16, v88
  v_and_b32 v124, 0xffff0000, v88
  v_fmac_f32 v12, v58, v123
  v_fmac_f32 v13, v58, v124
  v_lshlrev_b32 v125, 16, v89
  v_and_b32 v126, 0xffff0000, v89
  v_fmac_f32 v14, v58, v125
  v_fmac_f32 v15, v58, v126
  v_lshlrev_b32 v123, 16, v90
  v_and_b32 v124, 0xffff0000, v90
  v_fmac_f32 v16, v58, v123
  v_fmac_f32 v17, v58, v124
  v_lshlrev_b32 v125, 16, v91
  v_and_b32 v126, 0xffff0000, v91
  v_fmac_f32 v18, v58, v125
  v_fmac_f32 v19, v58, v126
  v_lshlrev_b32 v123, 16, v92
  v_and_b32 v124, 0xffff0000, v92
  v_fmac_f32 v20, v58, v123
  v_fmac_f32 v21, v58, v124
  v_lshlrev_b32 v125, 16, v93
  v_and_b32 v126, 0xffff0000, v93
  v_fmac_f32 v22, v58, v125
  v_fmac_f32 v23, v58, v126
  v_lshlrev_b32 v123, 16, v94
  v_and_b32 v124, 0xffff0000, v94
  v_fmac_f32 v24, v58, v123
  v_fmac_f32 v25, v58, v124
  v_lshlrev_b32 v125, 16, v95
  v_and_b32 v126, 0xffff0000, v95
  v_fmac_f32 v26, v58, v125
  v_fmac_f32 v27, v58, v126
  s_waitcnt vmcnt(0)
  v_lshlrev_b32 v123, 16, v96
  v_and_b32 v124, 0xffff0000, v96
  v_fmac_f32 v4, v59, v123
  v_fmac_f32 v5, v59, v124
  v_lshlrev_b32 v125, 16, v97
  v_and_b32 v126, 0xffff0000, v97
  v_fmac_f32 v6, v59, v125
  v_fmac_f32 v7, v59, v126
  v_lshlrev_b32 v123, 16, v98
  v_and_b32 v124, 0xffff0000, v98
  v_fmac_f32 v8, v59, v123
  v_fmac_f32 v9, v59, v124
  v_lshlrev_b32 v125, 16, v99
  v_and_b32 v126, 0xffff0000, v99
  v_fmac_f32 v10, v59, v125
  v_fmac_f32 v11, v59, v126
  v_lshlrev_b32 v123, 16, v100
  v_and_b32 v124, 0xffff0000, v100
  v_fmac_f32 v12, v59, v123
  v_fmac_f32 v13, v59, v124
  v_lshlrev_b32 v125, 16, v101
  v_and_b32 v126, 0xffff0000, v101
  v_fmac_f32 v14, v59, v125
  v_fmac_f32 v15, v59, v126
  v_lshlrev_b32 v123, 16, v102
  v_and_b32 v124, 0xffff0000, v102
  v_fmac_f32 v16, v59, v123
  v_fmac_f32 v17, v59, v124
  v_lshlrev_b32 v125, 16, v103
  v_and_b32 v126, 0xffff0000, v103
  v_fmac_f32 v18, v59, v125
  v_fmac_f32 v19, v59, v126
  v_lshlrev_b32 v123, 16, v104
  v_and_b32 v124, 0xffff0000, v104
  v_fmac_f32 v20, v59, v123
  v_fmac_f32 v21, v59, v124
  v_lshlrev_b32 v125, 16, v105
  v_and_b32 v126, 0xffff0000, v105
  v_fmac_f32 v22, v59, v125
  v_fmac_f32 v23, v59, v126
  v_lshlrev_b32 v123, 16, v106
  v_and_b32 v124, 0xffff0000, v106
  v_fmac_f32 v24, v59, v123
  v_fmac_f32 v25, v59, v124
  v_lshlrev_b32 v125, 16, v107
  v_and_b32 v126, 0xffff0000, v107
  v_fmac_f32 v26, v59, v125
  v_fmac_f32 v27, v59, v126
  v_lshrrev_b32 v2, 3, v0
  v_lshlrev_b32 v127, 2, v2
  ds_write_b32 v127, v121 offset:24576
  s_waitcnt lgkmcnt(0)
  s_barrier
  v_mov_b32 v126, 0
  ds_read_b128 v[60:63], v126 offset:24576
  ds_read_b128 v[64:67], v126 offset:24592
  ds_read_b128 v[68:71], v126 offset:24608
  ds_read_b128 v[72:75], v126 offset:24624
  ds_read_b128 v[76:79], v126 offset:24640
  ds_read_b128 v[80:83], v126 offset:24656
  ds_read_b128 v[84:87], v126 offset:24672
  ds_read_b128 v[88:91], v126 offset:24688
  s_waitcnt lgkmcnt(0)
  v_max3_f32 v125, v60, v61, v62
  v_max3_f32 v125, v125, v63, v64
  v_max3_f32 v125, v125, v65, v66
  v_max3_f32 v125, v125, v67, v68
  v_max3_f32 v125, v125, v69, v70
  v_max3_f32 v125, v125, v71, v72
  v_max3_f32 v125, v125, v73, v74
  v_max3_f32 v125, v125, v75, v76
  v_max3_f32 v125, v125, v77, v78
  v_max3_f32 v125, v125, v79, v80
  v_max3_f32 v125, v125, v81, v82
  v_max3_f32 v125, v125, v83, v84
  v_max3_f32 v125, v125, v85, v86
  v_max3_f32 v125, v125, v87, v88
  v_max3_f32 v125, v125, v89, v90
  v_max_f32 v125, v125, v91
  v_sub_f32 v124, v121, v125
  v_exp_f32 v124, v124
  s_nop 0
  v_mul_f32 v4, v124, v4
  v_mul_f32 v5, v124, v5
  v_mul_f32 v6, v124, v6
  v_mul_f32 v7, v124, v7
  v_mul_f32 v8, v124, v8
  v_mul_f32 v9, v124, v9
  v_mul_f32 v10, v124, v10
  v_mul_f32 v11, v124, v11
  v_mul_f32 v12, v124, v12
  v_mul_f32 v13, v124, v13
  v_mul_f32 v14, v124, v14
  v_mul_f32 v15, v124, v15
  v_mul_f32 v16, v124, v16
  v_mul_f32 v17, v124, v17
  v_mul_f32 v18, v124, v18
  v_mul_f32 v19, v124, v19
  v_mul_f32 v20, v124, v20
  v_mul_f32 v21, v124, v21
  v_mul_f32 v22, v124, v22
  v_mul_f32 v23, v124, v23
  v_mul_f32 v24, v124, v24
  v_mul_f32 v25, v124, v25
  v_mul_f32 v26, v124, v26
  v_mul_f32 v27, v124, v27
  v_mul_f32 v122, v124, v122
  v_mul_u32_u24 v126, 768, v2
  v_and_b32 v3, 7, v0
  v_lshl_add_u32 v126, v3, 5, v126
  ds_write_b128 v126, v[4:7] offset:0
  ds_write_b128 v126, v[8:11] offset:16
  ds_write_b128 v126, v[12:15] offset:256
  ds_write_b128 v126, v[16:19] offset:272
  ds_write_b128 v126, v[20:23] offset:512
  ds_write_b128 v126, v[24:27] offset:528
  ds_write_b32 v127, v122 offset:24704
  s_waitcnt lgkmcnt(0)
  s_barrier
  v_cmp_gt_u32 vcc, 192, v0
  s_and_saveexec_b64 s[26:27], vcc
  s_cbranch_execz L_part_end
  v_lshlrev_b32 v126, 2, v0
  ds_read_b32 v60, v126 offset:0
  ds_read_b32 v61, v126 offset:768
  ds_read_b32 v62, v126 offset:1536
  ds_read_b32 v63, v126 offset:2304
  ds_read_b32 v64, v126 offset:3072
  ds_read_b32 v65, v126 offset:3840
  ds_read_b32 v66, v126 offset:4608
  ds_read_b32 v67, v126 offset:5376
  ds_read_b32 v68, v126 offset:6144
  ds_read_b32 v69, v126 offset:6912
  ds_read_b32 v70, v126 offset:7680
  ds_read_b32 v71, v126 offset:8448
  ds_read_b32 v72, v126 offset:9216
  ds_read_b32 v73, v126 offset:9984
  ds_read_b32 v74, v126 offset:10752
  ds_read_b32 v75, v126 offset:11520
  ds_read_b32 v76, v126 offset:12288
  ds_read_b32 v77, v126 offset:13056
  ds_read_b32 v78, v126 offset:13824
  ds_read_b32 v79, v126 offset:14592
  ds_read_b32 v80, v126 offset:15360
  ds_read_b32 v81, v126 offset:16128
  ds_read_b32 v82, v126 offset:16896
  ds_read_b32 v83, v126 offset:17664
  ds_read_b32 v84, v126 offset:18432
  ds_read_b32 v85, v126 offset:19200
  ds_read_b32 v86, v126 offset:19968
  ds_read_b32 v87, v126 offset:20736
  ds_read_b32 v88, v126 offset:21504
  ds_read_b32 v89, v126 offset:22272
  ds_read_b32 v90, v126 offset:23040
  ds_read_b32 v91, v126 offset:23808
  v_mov_b32 v127, 0
  ds_read_b128 v[92:95], v127 offset:24704
  ds_read_b128 v[96:99], v127 offset:24720
  ds_read_b128 v[100:103], v127 offset:24736
  ds_read_b128 v[104:107], v127 offset:24752
  ds_read_b128 v[108:111], v127 offset:24768
  ds_read_b128 v[112:115], v127 offset:24784
  ds_read_b128 v[116:119], v127 offset:24800
  ds_read_b128 v[120:123], v127 offset:24816
  s_waitcnt lgkmcnt(0)
  v_add_f32 v60, v60, v61
  v_add_f32 v60, v60, v62
  v_add_f32 v60, v60, v63
  v_add_f32 v60, v60, v64
  v_add_f32 v60, v60, v65
  v_add_f32 v60, v60, v66
  v_add_f32 v60, v60, v67
  v_add_f32 v60, v60, v68
  v_add_f32 v60, v60, v69
  v_add_f32 v60, v60, v70
  v_add_f32 v60, v60, v71
  v_add_f32 v60, v60, v72
  v_add_f32 v60, v60, v73
  v_add_f32 v60, v60, v74
  v_add_f32 v60, v60, v75
  v_add_f32 v60, v60, v76
  v_add_f32 v60, v60, v77
  v_add_f32 v60, v60, v78
  v_add_f32 v60, v60, v79
  v_add_f32 v60, v60, v80
  v_add_f32 v60, v60, v81
  v_add_f32 v60, v60, v82
  v_add_f32 v60, v60, v83
  v_add_f32 v60, v60, v84
  v_add_f32 v60, v60, v85
  v_add_f32 v60, v60, v86
  v_add_f32 v60, v60, v87
  v_add_f32 v60, v60, v88
  v_add_f32 v60, v60, v89
  v_add_f32 v60, v60, v90
  v_add_f32 v60, v60, v91
  v_add_f32 v92, v92, v93
  v_add_f32 v92, v92, v94
  v_add_f32 v92, v92, v95
  v_add_f32 v92, v92, v96
  v_add_f32 v92, v92, v97
  v_add_f32 v92, v92, v98
  v_add_f32 v92, v92, v99
  v_add_f32 v92, v92, v100
  v_add_f32 v92, v92, v101
  v_add_f32 v92, v92, v102
  v_add_f32 v92, v92, v103
  v_add_f32 v92, v92, v104
  v_add_f32 v92, v92, v105
  v_add_f32 v92, v92, v106
  v_add_f32 v92, v92, v107
  v_add_f32 v92, v92, v108
  v_add_f32 v92, v92, v109
  v_add_f32 v92, v92, v110
  v_add_f32 v92, v92, v111
  v_add_f32 v92, v92, v112
  v_add_f32 v92, v92, v113
  v_add_f32 v92, v92, v114
  v_add_f32 v92, v92, v115
  v_add_f32 v92, v92, v116
  v_add_f32 v92, v92, v117
  v_add_f32 v92, v92, v118
  v_add_f32 v92, v92, v119
  v_add_f32 v92, v92, v120
  v_add_f32 v92, v92, v121
  v_add_f32 v92, v92, v122
  v_add_f32 v92, v92, v123
  s_mul_i32 s28, s2, 768
  buffer_store_dword v60, v126, s[16:19], s28 offen
  v_mov_b32 v2, v125
  v_mov_b32 v3, v92
  v_cmp_eq_u32 vcc, 0, v0
  s_and_saveexec_b64 s[26:27], vcc
  s_cbranch_execz L_part_end
  s_lshl_b32 s28, s2, 3
  s_add_u32 s28, s28, 1048576
  v_mov_b32 v126, 0
  buffer_store_dwordx2 v[2:3], v126, s[16:19], s28 offen
L_part_end:
  s_endpgm
.globl attn_comb_kernel
.p2align 8
.type attn_comb_kernel,@function
attn_comb_kernel:
  s_cmp_ge_u32 s2, 32
  s_cbranch_scc1 L_comb_end
  s_load_dwordx2 s[12:13], s[0:1], 24
  s_load_dwordx2 s[16:17], s[0:1], 40
  v_cmp_gt_u32 vcc, 192, v0
  s_and_saveexec_b64 s[26:27], vcc
  s_cbranch_execz L_comb_end
  s_waitcnt lgkmcnt(0)
  s_mov_b32 s14, 12288
  s_mov_b32 s15, 0x00020000
  s_mov_b32 s18, 1056768
  s_mov_b32 s19, 0x00020000
  s_mul_i32 s20, s2, 24576
  s_lshl_b32 s21, s2, 8
  s_add_u32 s21, s21, 1048576
  v_lshlrev_b32 v1, 2, v0
  v_mov_b32 v2, 0
  buffer_load_dwordx4 v[4:7], v2, s[16:19], s21 offen offset:0
  buffer_load_dwordx4 v[8:11], v2, s[16:19], s21 offen offset:16
  buffer_load_dwordx4 v[12:15], v2, s[16:19], s21 offen offset:32
  buffer_load_dwordx4 v[16:19], v2, s[16:19], s21 offen offset:48
  buffer_load_dwordx4 v[20:23], v2, s[16:19], s21 offen offset:64
  buffer_load_dwordx4 v[24:27], v2, s[16:19], s21 offen offset:80
  buffer_load_dwordx4 v[28:31], v2, s[16:19], s21 offen offset:96
  buffer_load_dwordx4 v[32:35], v2, s[16:19], s21 offen offset:112
  buffer_load_dwordx4 v[36:39], v2, s[16:19], s21 offen offset:128
  buffer_load_dwordx4 v[40:43], v2, s[16:19], s21 offen offset:144
  buffer_load_dwordx4 v[44:47], v2, s[16:19], s21 offen offset:160
  buffer_load_dwordx4 v[48:51], v2, s[16:19], s21 offen offset:176
  buffer_load_dwordx4 v[52:55], v2, s[16:19], s21 offen offset:192
  buffer_load_dwordx4 v[56:59], v2, s[16:19], s21 offen offset:208
  buffer_load_dwordx4 v[60:63], v2, s[16:19], s21 offen offset:224
  buffer_load_dwordx4 v[64:67], v2, s[16:19], s21 offen offset:240
  buffer_load_dword v68, v1, s[16:19], s20 offen offset:0
  buffer_load_dword v69, v1, s[16:19], s20 offen offset:768
  buffer_load_dword v70, v1, s[16:19], s20 offen offset:1536
  buffer_load_dword v71, v1, s[16:19], s20 offen offset:2304
  buffer_load_dword v72, v1, s[16:19], s20 offen offset:3072
  s_add_u32 s20, s20, 3840
  buffer_load_dword v73, v1, s[16:19], s20 offen offset:0
  buffer_load_dword v74, v1, s[16:19], s20 offen offset:768
  buffer_load_dword v75, v1, s[16:19], s20 offen offset:1536
  buffer_load_dword v76, v1, s[16:19], s20 offen offset:2304
  buffer_load_dword v77, v1, s[16:19], s20 offen offset:3072
  s_add_u32 s20, s20, 3840
  buffer_load_dword v78, v1, s[16:19], s20 offen offset:0
  buffer_load_dword v79, v1, s[16:19], s20 offen offset:768
  buffer_load_dword v80, v1, s[16:19], s20 offen offset:1536
  buffer_load_dword v81, v1, s[16:19], s20 offen offset:2304
  buffer_load_dword v82, v1, s[16:19], s20 offen offset:3072
  s_add_u32 s20, s20, 3840
  buffer_load_dword v83, v1, s[16:19], s20 offen offset:0
  buffer_load_dword v84, v1, s[16:19], s20 offen offset:768
  buffer_load_dword v85, v1, s[16:19], s20 offen offset:1536
  buffer_load_dword v86, v1, s[16:19], s20 offen offset:2304
  buffer_load_dword v87, v1, s[16:19], s20 offen offset:3072
  s_add_u32 s20, s20, 3840
  buffer_load_dword v88, v1, s[16:19], s20 offen offset:0
  buffer_load_dword v89, v1, s[16:19], s20 offen offset:768
  buffer_load_dword v90, v1, s[16:19], s20 offen offset:1536
  buffer_load_dword v91, v1, s[16:19], s20 offen offset:2304
  buffer_load_dword v92, v1, s[16:19], s20 offen offset:3072
  s_add_u32 s20, s20, 3840
  buffer_load_dword v93, v1, s[16:19], s20 offen offset:0
  buffer_load_dword v94, v1, s[16:19], s20 offen offset:768
  buffer_load_dword v95, v1, s[16:19], s20 offen offset:1536
  buffer_load_dword v96, v1, s[16:19], s20 offen offset:2304
  buffer_load_dword v97, v1, s[16:19], s20 offen offset:3072
  s_add_u32 s20, s20, 3840
  buffer_load_dword v98, v1, s[16:19], s20 offen offset:0
  buffer_load_dword v99, v1, s[16:19], s20 offen offset:768
  s_waitcnt vmcnt(32)
  v_max_f32 v3, v4, v6
  v_max_f32 v3, v3, v8
  v_max_f32 v3, v3, v10
  v_max_f32 v3, v3, v12
  v_max_f32 v3, v3, v14
  v_max_f32 v3, v3, v16
  v_max_f32 v3, v3, v18
  v_max_f32 v3, v3, v20
  v_max_f32 v3, v3, v22
  v_max_f32 v3, v3, v24
  v_max_f32 v3, v3, v26
  v_max_f32 v3, v3, v28
  v_max_f32 v3, v3, v30
  v_max_f32 v3, v3, v32
  v_max_f32 v3, v3, v34
  v_max_f32 v3, v3, v36
  v_max_f32 v3, v3, v38
  v_max_f32 v3, v3, v40
  v_max_f32 v3, v3, v42
  v_max_f32 v3, v3, v44
  v_max_f32 v3, v3, v46
  v_max_f32 v3, v3, v48
  v_max_f32 v3, v3, v50
  v_max_f32 v3, v3, v52
  v_max_f32 v3, v3, v54
  v_max_f32 v3, v3, v56
  v_max_f32 v3, v3, v58
  v_max_f32 v3, v3, v60
  v_max_f32 v3, v3, v62
  v_max_f32 v3, v3, v64
  v_max_f32 v3, v3, v66
  v_sub_f32 v4, v4, v3
  v_sub_f32 v6, v6, v3
  v_sub_f32 v8, v8, v3
  v_sub_f32 v10, v10, v3
  v_sub_f32 v12, v12, v3
  v_sub_f32 v14, v14, v3
  v_sub_f32 v16, v16, v3
  v_sub_f32 v18, v18, v3
  v_sub_f32 v20, v20, v3
  v_sub_f32 v22, v22, v3
  v_sub_f32 v24, v24, v3
  v_sub_f32 v26, v26, v3
  v_sub_f32 v28, v28, v3
  v_sub_f32 v30, v30, v3
  v_sub_f32 v32, v32, v3
  v_sub_f32 v34, v34, v3
  v_sub_f32 v36, v36, v3
  v_sub_f32 v38, v38, v3
  v_sub_f32 v40, v40, v3
  v_sub_f32 v42, v42, v3
  v_sub_f32 v44, v44, v3
  v_sub_f32 v46, v46, v3
  v_sub_f32 v48, v48, v3
  v_sub_f32 v50, v50, v3
  v_sub_f32 v52, v52, v3
  v_sub_f32 v54, v54, v3
  v_sub_f32 v56, v56, v3
  v_sub_f32 v58, v58, v3
  v_sub_f32 v60, v60, v3
  v_sub_f32 v62, v62, v3
  v_sub_f32 v64, v64, v3
  v_sub_f32 v66, v66, v3
  v_exp_f32 v4, v4
  v_exp_f32 v6, v6
  v_exp_f32 v8, v8
  v_exp_f32 v10, v10
  v_exp_f32 v12, v12
  v_exp_f32 v14, v14
  v_exp_f32 v16, v16
  v_exp_f32 v18, v18
  v_exp_f32 v20, v20
  v_exp_f32 v22, v22
  v_exp_f32 v24, v24
  v_exp_f32 v26, v26
  v_exp_f32 v28, v28
  v_exp_f32 v30, v30
  v_exp_f32 v32, v32
  v_exp_f32 v34, v34
  v_exp_f32 v36, v36
  v_exp_f32 v38, v38
  v_exp_f32 v40, v40
  v_exp_f32 v42, v42
  v_exp_f32 v44, v44
  v_exp_f32 v46, v46
  v_exp_f32 v48, v48
  v_exp_f32 v50, v50
  v_exp_f32 v52, v52
  v_exp_f32 v54, v54
  v_exp_f32 v56, v56
  v_exp_f32 v58, v58
  v_exp_f32 v60, v60
  v_exp_f32 v62, v62
  v_exp_f32 v64, v64
  v_exp_f32 v66, v66
  s_nop 0
  v_mul_f32 v100, v4, v5
  v_fmac_f32 v100, v6, v7
  v_fmac_f32 v100, v8, v9
  v_fmac_f32 v100, v10, v11
  v_fmac_f32 v100, v12, v13
  v_fmac_f32 v100, v14, v15
  v_fmac_f32 v100, v16, v17
  v_fmac_f32 v100, v18, v19
  v_fmac_f32 v100, v20, v21
  v_fmac_f32 v100, v22, v23
  v_fmac_f32 v100, v24, v25
  v_fmac_f32 v100, v26, v27
  v_fmac_f32 v100, v28, v29
  v_fmac_f32 v100, v30, v31
  v_fmac_f32 v100, v32, v33
  v_fmac_f32 v100, v34, v35
  v_fmac_f32 v100, v36, v37
  v_fmac_f32 v100, v38, v39
  v_fmac_f32 v100, v40, v41
  v_fmac_f32 v100, v42, v43
  v_fmac_f32 v100, v44, v45
  v_fmac_f32 v100, v46, v47
  v_fmac_f32 v100, v48, v49
  v_fmac_f32 v100, v50, v51
  v_fmac_f32 v100, v52, v53
  v_fmac_f32 v100, v54, v55
  v_fmac_f32 v100, v56, v57
  v_fmac_f32 v100, v58, v59
  v_fmac_f32 v100, v60, v61
  v_fmac_f32 v100, v62, v63
  v_fmac_f32 v100, v64, v65
  v_fmac_f32 v100, v66, v67
  s_waitcnt vmcnt(0)
  v_mul_f32 v101, v4, v68
  v_fmac_f32 v101, v6, v69
  v_fmac_f32 v101, v8, v70
  v_fmac_f32 v101, v10, v71
  v_fmac_f32 v101, v12, v72
  v_fmac_f32 v101, v14, v73
  v_fmac_f32 v101, v16, v74
  v_fmac_f32 v101, v18, v75
  v_fmac_f32 v101, v20, v76
  v_fmac_f32 v101, v22, v77
  v_fmac_f32 v101, v24, v78
  v_fmac_f32 v101, v26, v79
  v_fmac_f32 v101, v28, v80
  v_fmac_f32 v101, v30, v81
  v_fmac_f32 v101, v32, v82
  v_fmac_f32 v101, v34, v83
  v_fmac_f32 v101, v36, v84
  v_fmac_f32 v101, v38, v85
  v_fmac_f32 v101, v40, v86
  v_fmac_f32 v101, v42, v87
  v_fmac_f32 v101, v44, v88
  v_fmac_f32 v101, v46, v89
  v_fmac_f32 v101, v48, v90
  v_fmac_f32 v101, v50, v91
  v_fmac_f32 v101, v52, v92
  v_fmac_f32 v101, v54, v93
  v_fmac_f32 v101, v56, v94
  v_fmac_f32 v101, v58, v95
  v_fmac_f32 v101, v60, v96
  v_fmac_f32 v101, v62, v97
  v_fmac_f32 v101, v64, v98
  v_fmac_f32 v101, v66, v99
  v_rcp_f32 v100, v100
  s_nop 0
  v_mul_f32 v101, v101, v100
  v_cvt_pk_bf16_f32 v101, v101, v101
  v_lshlrev_b32 v1, 1, v0
  s_mul_i32 s20, s2, 384
  buffer_store_short v101, v1, s[12:15], s20 offen
L_comb_end:
  s_endpgm
.section .rodata,"a"
.p2align 6
.amdhsa_kernel attn_part_kernel
  .amdhsa_next_free_vgpr 128
  .amdhsa_next_free_sgpr 32
  .amdhsa_accum_offset 128
  .amdhsa_group_segment_fixed_size 0
  .amdhsa_kernarg_size 48
  .amdhsa_user_sgpr_count 2
  .amdhsa_user_sgpr_kernarg_segment_ptr 1
  .amdhsa_system_sgpr_workgroup_id_x 1
.end_amdhsa_kernel
.p2align 6
.amdhsa_kernel attn_comb_kernel
  .amdhsa_next_free_vgpr 104
  .amdhsa_next_free_sgpr 32
  .amdhsa_accum_offset 104
  .amdhsa_group_segment_fixed_size 0
  .amdhsa_kernarg_size 48
  .amdhsa_user_sgpr_count 2
  .amdhsa_user_sgpr_kernarg_segment_ptr 1
  .amdhsa_system_sgpr_workgroup_id_x 1
.end_amdhsa_kernel
```
